```python
import torch

def _softmax(x, axis=-1):
    return torch.softmax(x, dim=axis)
def _gelu(x):
    return torch.nn.functional.gelu(x, approximate="tanh")
def _silu(x):
    return torch.nn.functional.silu(x)
def _sigmoid(x):
    return torch.sigmoid(x)
def _layernorm(x, axis=-1, eps=1e-5):
    m = x.mean(dim=axis, keepdim=True)
    v = x.var(dim=axis, keepdim=True, unbiased=False)
    return (x - m) / torch.sqrt(v + eps)
def _scatter_add(tgt, idx, src, axis=0):
    return tgt.clone().index_add_(axis, idx, src)
def _segment_sum(src, seg, n):
    out = torch.zeros((n,) + src.shape[1:], dtype=src.dtype)
    return out.index_add_(0, seg, src)
def _pad(x, pw):
    flat = tuple(v for pair in reversed(pw) for v in pair)
    return torch.nn.functional.pad(x, flat)

kernel_name = 'parallel_sum__gqa_block_cached__glu_gated_glu__decode'

def setup_inputs():

    _w = (lambda a: (lambda t: t.to(torch.bfloat16) if t.is_floating_point() else t)(torch.as_tensor(a)))
    def _A_setup():
        B, Sq, D = 2, 1, 640
        Hq, Hkv, Sk, Dh = 32, 32, 8192, 192
        assert Hq % Hkv == 0, (Hq, Hkv)
        return {
            "x": _w((lambda *s: torch.randn(*s, dtype=torch.bfloat16) * 0.05)(B, Sq, D)),
            "k_cache": _w((lambda *s: torch.randn(*s, dtype=torch.bfloat16) * 3.2)(B, Hkv, Sk, Dh)),
            "v_cache": _w((lambda *s: torch.randn(*s, dtype=torch.bfloat16) * 1.6)(B, Hkv, Sk, Dh)),
            "wq": _w((lambda *s: torch.randn(*s, dtype=torch.bfloat16) * 3.2)(D, Hq * Dh) * (D ** -0.5)),
            "wo": _w((lambda *s: torch.randn(*s, dtype=torch.bfloat16) * 1.6)(Hq * Dh, D) * ((Hq * Dh) ** -0.5)),
        }
    _A_in = _A_setup()

    def _B_setup():
        B, S, D, F = 2, 1, 640, 1536
        return {
            "x": _w((lambda *s: torch.randn(*s, dtype=torch.bfloat16) * 0.05)(B, S, D)),
            "w_gate": _w((lambda *s: torch.randn(*s, dtype=torch.bfloat16) * 0.2)(D, F)),
            "w_up": _w((lambda *s: torch.randn(*s, dtype=torch.bfloat16) * 0.05)(D, F)),
            "w_down": _w((lambda *s: torch.randn(*s, dtype=torch.bfloat16) * 0.05)(F, D)),
        }
    _B_in = _B_setup()

    return {
        "A_x": _A_in["x"],
        "A_k_cache": _A_in["k_cache"],
        "A_v_cache": _A_in["v_cache"],
        "A_wq": _A_in["wq"],
        "A_wo": _A_in["wo"],
        "B_x": _B_in["x"],
        "B_w_gate": _B_in["w_gate"],
        "B_w_up": _B_in["w_up"],
        "B_w_down": _B_in["w_down"],
    }

def reference(A_x, A_k_cache, A_v_cache, A_wq, A_wo, B_x, B_w_gate, B_w_up, B_w_down):
    def _A_ref(x, k_cache, v_cache, wq, wo):
        B, Sq, D = x.shape
        Hq, Dh = 32, 192
        Hkv = k_cache.shape[1]
        rep = Hq // Hkv
        q = (lambda x, *d: x.permute(*d))((x @ wq).reshape(B, Sq, Hq, Dh), 0, 2, 1, 3)
        k = (lambda x, n, axis: torch.repeat_interleave(x, n, dim=axis))(k_cache, rep, axis=1)
        v = (lambda x, n, axis: torch.repeat_interleave(x, n, dim=axis))(v_cache, rep, axis=1)
        scores = torch.einsum("bhqd,bhkd->bhqk", q, k) * (Dh ** -0.5)
        p = _softmax(scores, axis=-1)
        o = torch.einsum("bhqk,bhkd->bhqd", p, v)
        return (lambda x, *d: x.permute(*d))(o, 0, 2, 1, 3).reshape(B, Sq, Hq * Dh) @ wo

    def _B_ref(x, w_gate, w_up, w_down):
        g = torch.einsum("bsd,df->bsf", x, w_gate)
        u = torch.einsum("bsd,df->bsf", x, w_up)
        h = _sigmoid(g) * u
        return torch.einsum("bsf,fd->bsd", h, w_down)

    x = A_x
    xn = _layernorm(x, axis=-1)
    return x + _A_ref(xn, A_k_cache, A_v_cache, A_wq, A_wo) + _B_ref(xn, B_w_gate, B_w_up, B_w_down)
```

```asm
; @launch grid=(256,1,1) block=(1024,1,1) lds=163840
.amdgcn_target "amdgcn-amd-amdhsa--gfx950"
.text
.globl parallel_sum__gqa_block_cached__glu_gated_glu__decode_kernel
.p2align 8
.type parallel_sum__gqa_block_cached__glu_gated_glu__decode_kernel,@function
parallel_sum__gqa_block_cached__glu_gated_glu__decode_kernel:
    s_load_dwordx16 s[16:31], s[0:1], 0
    s_load_dwordx8 s[32:39], s[0:1], 64
    s_cmp_ge_u32 s2, 256
    s_cbranch_scc1 L_end
    v_lshrrev_b32 v1, 6, v0
    v_and_b32 v0, 63, v0
    v_readfirstlane_b32 s3, v1
    s_and_b32 s4, s2, 7
    s_lshr_b32 s5, s2, 3
    s_lshr_b32 s6, s5, 3
    s_lshl_b32 s4, s4, 2
    s_add_u32 s4, s4, s6
    s_and_b32 s5, s5, 7
    s_cmp_eq_u32 s6, 3
    s_cselect_b32 s49, 2, 1
    s_cmp_lt_u32 s5, 6
    s_cselect_b32 s49, 0, s49
    s_cmp_eq_u32 s6, 3
    s_cselect_b32 s54, 20, 40
    s_mul_i32 s55, s5, s54
    s_mul_i32 s7, s5, 60
    s_sub_u32 s7, s7, 240
    s_cmp_eq_u32 s49, 2
    s_cselect_b32 s55, s7, s55
    s_mul_i32 s7, s4, 240
    s_add_u32 s55, s55, s7
    s_lshl_b32 s55, s55, 10
    s_mov_b32 s7, 0x400000
    v_mov_b32 v1, 0
    s_cmp_eq_u32 s3, 0
    s_cbranch_scc1 L_loader
    s_barrier
    s_branch L_notloader
L_loader:
    v_lshlrev_b32 v2, 2, v0
    ds_write_b32 v2, v1
    s_setprio 3
    v_lshrrev_b32 v4, 3, v0
    v_and_b32 v5, 7, v0
    v_lshlrev_b32 v9, 4, v0
    s_and_b32 s46, s5, 1
    s_mul_i32 s46, s46, 3932160
    s_mul_i32 s47, s4, 384
    s_add_u32 s46, s46, s47
    s_lshr_b32 s47, s5, 1
    s_lshl_b32 s47, s47, 7
    s_add_u32 s46, s46, s47
    s_lshr_b32 s48, s4, 2
    s_sub_u32 s47, s4, s48
    s_lshl_b32 s47, s47, 7
    s_cmp_eq_u32 s49, 0
    s_cselect_b32 s46, s46, s47
    s_movk_i32 s45, 3072
    s_cselect_b32 s45, 12288, s45
    v_mul_u32_u24 v8, s45, v4
    v_lshl_add_u32 v8, v5, 4, v8
    s_lshl_b32 s45, s45, 3
    s_mov_b32 m0, 155648
    s_mov_b32 s11, 0x20000
    s_movk_i32 s10, 2560
    v_mov_b32 v2, 1
    s_waitcnt lgkmcnt(0)
    s_mov_b32 s64, s16
    s_mov_b32 s65, s17
    s_movk_i32 s66, 2560
    s_mov_b32 s67, 0x20000
    s_mov_b32 m0, 155648
    s_nop 0
    buffer_load_dwordx4 v9, s[64:67], 0 offen lds
    buffer_load_dwordx4 v9, s[64:67], 0 offen offset:1024 lds
    buffer_load_dwordx4 v9, s[64:67], 0 offen offset:2048 lds
    s_cmp_eq_u32 s5, 6
    s_cselect_b32 s8, s28, s30
    s_cselect_b32 s9, s29, s31
    s_cmp_eq_u32 s49, 0
    s_cselect_b32 s8, s22, s8
    s_cselect_b32 s9, s23, s9
    s_mov_b32 s10, 7864320
    s_cmp_eq_u32 s49, 1
    s_mov_b32 m0, 114688
    s_cselect_b32 s10, 1966080, s10
    s_cmp_eq_u32 s49, 2
    s_cbranch_scc1 L_ld_bar
    buffer_load_dwordx4 v8, s[8:11], s46 offen nt lds
    s_add_u32 m0, m0, 1024
    s_add_u32 s46, s46, s45
    buffer_load_dwordx4 v8, s[8:11], s46 offen nt lds
    s_add_u32 m0, m0, 1024
    s_add_u32 s46, s46, s45
    buffer_load_dwordx4 v8, s[8:11], s46 offen nt lds
    s_add_u32 m0, m0, 1024
    s_add_u32 s46, s46, s45
    buffer_load_dwordx4 v8, s[8:11], s46 offen nt lds
    s_add_u32 m0, m0, 1024
    s_add_u32 s46, s46, s45
    buffer_load_dwordx4 v8, s[8:11], s46 offen nt lds
    s_add_u32 m0, m0, 1024
    s_add_u32 s46, s46, s45
L_ld_bar:
    s_barrier
    s_getpc_b64 s[58:59]
L_rtpc:
    s_lshl_b32 s56, s4, 2
    s_add_u32 s56, s56, L_rtab-L_rtpc
    s_load_dword s57, s[58:59], s56
    s_cmp_eq_u32 s49, 2
    s_cbranch_scc1 L_ld_p2
L_ld_pre:
    s_waitcnt vmcnt(20)
    buffer_load_dwordx4 v8, s[8:11], s46 offen nt lds
    s_add_u32 m0, m0, 1024
    s_add_u32 s46, s46, s45
    s_cmp_ge_u32 m0, 136192
    s_cselect_b32 s47, 1, 0
    v_mov_b32 v3, s47
    ds_write_b32 v1, v3 offset:36
    s_waitcnt vmcnt(20)
    buffer_load_dwordx4 v8, s[8:11], s46 offen nt lds
    s_add_u32 m0, m0, 1024
    s_add_u32 s46, s46, s45
    s_waitcnt vmcnt(20)
    buffer_load_dwordx4 v8, s[8:11], s46 offen nt lds
    s_add_u32 m0, m0, 1024
    s_add_u32 s46, s46, s45
    s_waitcnt vmcnt(20)
    buffer_load_dwordx4 v8, s[8:11], s46 offen nt lds
    s_add_u32 m0, m0, 1024
    s_add_u32 s46, s46, s45
    s_waitcnt vmcnt(20)
    buffer_load_dwordx4 v8, s[8:11], s46 offen nt lds
    s_add_u32 m0, m0, 1024
    s_add_u32 s46, s46, s45
    s_cmp_lt_u32 m0, 155648
    s_cbranch_scc1 L_ld_pre
L_ld_p2:
    s_cmp_eq_u32 s49, 2
    s_cselect_b32 s48, 60, s54
    s_lshl_b32 s48, s48, 10
    s_add_u32 s48, s48, 65536
    s_mov_b32 m0, 65536
    s_cmp_eq_u32 s49, 1
    s_cbranch_scc1 L_ld_pre2
    s_mov_b32 s8, s24
    s_mov_b32 s9, s25
L_ld_pp:
    s_waitcnt vmcnt(40)
    buffer_load_dwordx4 v9, s[8:11], s55 offen nt lds
    buffer_load_dwordx4 v9, s[8:11], s55 offen  lds
    s_add_u32 m0, m0, 1024
    s_add_u32 s55, s55, 1024
    s_waitcnt vmcnt(40)
    buffer_load_dwordx4 v9, s[8:11], s55 offen nt lds
    buffer_load_dwordx4 v9, s[8:11], s55 offen  lds
    s_add_u32 m0, m0, 1024
    s_add_u32 s55, s55, 1024
    s_waitcnt vmcnt(40)
    buffer_load_dwordx4 v9, s[8:11], s55 offen nt lds
    buffer_load_dwordx4 v9, s[8:11], s55 offen  lds
    s_add_u32 m0, m0, 1024
    s_add_u32 s55, s55, 1024
    s_waitcnt vmcnt(40)
    buffer_load_dwordx4 v9, s[8:11], s55 offen nt lds
    buffer_load_dwordx4 v9, s[8:11], s55 offen  lds
    s_add_u32 m0, m0, 1024
    s_add_u32 s55, s55, 1024
    s_waitcnt vmcnt(40)
    buffer_load_dwordx4 v9, s[8:11], s55 offen nt lds
    buffer_load_dwordx4 v9, s[8:11], s55 offen  lds
    s_add_u32 m0, m0, 1024
    s_add_u32 s55, s55, 1024
    s_cmp_eq_u32 m0, 86016
    s_cbranch_scc0 L_ld_pp3
    s_waitcnt vmcnt(40)
    ds_write_b32 v1, v2 offset:112
L_ld_pp3:
    s_cmp_lt_u32 m0, s48
    s_cbranch_scc1 L_ld_pp
    s_branch L_ld_pe
L_ld_pre2:
    s_waitcnt vmcnt(20)
    buffer_load_dwordx4 v8, s[8:11], s46 offen nt lds
    s_add_u32 m0, m0, 1024
    s_add_u32 s46, s46, s45
    s_waitcnt vmcnt(20)
    buffer_load_dwordx4 v8, s[8:11], s46 offen nt lds
    s_add_u32 m0, m0, 1024
    s_add_u32 s46, s46, s45
    s_waitcnt vmcnt(20)
    buffer_load_dwordx4 v8, s[8:11], s46 offen nt lds
    s_add_u32 m0, m0, 1024
    s_add_u32 s46, s46, s45
    s_waitcnt vmcnt(20)
    buffer_load_dwordx4 v8, s[8:11], s46 offen nt lds
    s_add_u32 m0, m0, 1024
    s_add_u32 s46, s46, s45
    s_waitcnt vmcnt(20)
    buffer_load_dwordx4 v8, s[8:11], s46 offen nt lds
    s_add_u32 m0, m0, 1024
    s_add_u32 s46, s46, s45
    s_cmp_eq_u32 m0, 86016
    s_cbranch_scc0 L_ld_pre3
    s_waitcnt vmcnt(20)
    ds_write_b32 v1, v2 offset:112
L_ld_pre3:
    s_cmp_lt_u32 m0, s48
    s_cbranch_scc1 L_ld_pre2
L_ld_pe:
    v_lshlrev_b32 v6, 7, v4
    v_add_u32 v7, 0, v4
    v_mul_u32_u24 v7, 43, v7
    v_lshrrev_b32 v7, 8, v7
    v_xor_b32 v7, v7, v5
    v_lshl_add_u32 v10, v7, 4, v6
    v_add_u32 v7, 8, v4
    v_mul_u32_u24 v7, 43, v7
    v_lshrrev_b32 v7, 8, v7
    v_xor_b32 v7, v7, v5
    v_lshl_add_u32 v11, v7, 4, v6
    v_add_u32 v7, 16, v4
    v_mul_u32_u24 v7, 43, v7
    v_lshrrev_b32 v7, 8, v7
    v_xor_b32 v7, v7, v5
    v_lshl_add_u32 v12, v7, 4, v6
    v_add_u32 v7, 24, v4
    v_mul_u32_u24 v7, 43, v7
    v_lshrrev_b32 v7, 8, v7
    v_xor_b32 v7, v7, v5
    v_lshl_add_u32 v13, v7, 4, v6
    v_add_u32 v7, 32, v4
    v_mul_u32_u24 v7, 43, v7
    v_lshrrev_b32 v7, 8, v7
    v_xor_b32 v7, v7, v5
    v_lshl_add_u32 v14, v7, 4, v6
    v_add_u32 v7, 40, v4
    v_mul_u32_u24 v7, 43, v7
    v_lshrrev_b32 v7, 8, v7
    v_xor_b32 v7, v7, v5
    v_lshl_add_u32 v15, v7, 4, v6
    v_mov_b32 v3, 0
    v_mov_b32 v5, 8
    ds_write_b32 v1, v5 offset:28
    s_mul_i32 s40, s4, 3145728
    s_mov_b32 s41, 0
    s_mov_b32 s42, 16384
    s_mov_b32 s43, 0
    s_mov_b32 s50, 0
    s_mov_b32 s51, 0
    s_mov_b32 s52, 0
    s_mov_b32 s53, 0
    s_mov_b32 s54, 0
    s_mov_b32 s10, 201326592
L_ld_phase:
    s_lshr_b32 s44, s43, 1
    s_and_b32 s44, s44, 1
    s_mul_i32 s44, s44, 100663296
    s_add_u32 s44, s44, s40
    s_and_b32 s45, s43, 1
    s_cselect_b32 s8, s20, s18
    s_cselect_b32 s9, s21, s19
    s_cselect_b64 vcc, -1, 0
    v_cndmask_b32 v20, v10, v9, vcc
    v_cndmask_b32 v21, v11, v9, vcc
    v_cndmask_b32 v22, v12, v9, vcc
    v_cndmask_b32 v23, v13, v9, vcc
    v_cndmask_b32 v24, v14, v9, vcc
    v_cndmask_b32 v25, v15, v9, vcc
    s_waitcnt lgkmcnt(0)
    s_lshr_b32 s56, s43, 1
    s_lshl_b32 s56, s56, 3
    s_lshr_b32 s56, s57, s56
    s_cmp_eq_u32 s43, 3
    s_cselect_b32 s61, 30, 32
    s_mov_b32 s45, 0
L_ld_chunk:
    s_cmp_eq_u32 s41, 4
    s_cbranch_scc0 L_ld_n9
    s_cmp_eq_u32 s49, 2
    s_cbranch_scc1 L_ld_n9
    s_lshl_b32 s47, 8, s49
L_pl_1:
    ds_read_b32 v2, v1 offset:48
    s_waitcnt lgkmcnt(0)
    v_readfirstlane_b32 s46, v2
    s_cmp_ge_u32 s46, s47
    s_cbranch_scc1 L_pd_2
    s_sleep 1
    s_sub_u32 s7, s7, 1
    s_cbranch_scc0 L_pl_1
    s_endpgm
L_pd_2:
L_ld_n9:
    s_lshr_b32 s47, s41, 1
    s_sub_u32 s47, s47, 5
    s_waitcnt lgkmcnt(0)
    v_readfirstlane_b32 s50, v3
    v_readfirstlane_b32 s52, v5
    s_cmp_ge_i32 s50, s47
    s_cbranch_scc1 L_ld_go
    s_waitcnt vmcnt(0)
    s_add_u32 s51, s41, 1
    v_mov_b32 v2, s51
    ds_write_b32 v1, v2 offset:0
L_pl_3:
    ds_read_b32 v2, v4 offset:4
    s_waitcnt lgkmcnt(0)
    v_readfirstlane_b32 s46, v2
    s_cmp_ge_u32 s46, s47
    s_cbranch_scc1 L_pd_4
    s_sleep 1
    s_sub_u32 s7, s7, 1
    s_cbranch_scc0 L_pl_3
    s_endpgm
L_pd_4:
L_ld_go:
    s_add_u32 s46, s45, s5
    s_and_b32 s46, s46, 7
    s_add_u32 s47, s45, s56
    s_and_b32 s47, s47, 31
    s_lshl_b32 s47, s47, 3
    s_add_u32 s46, s46, s47
    s_mul_i32 s46, s46, 12288
    s_add_u32 s46, s46, s44
    s_cmp_ge_u32 s45, 26
    s_cselect_b32 s47, 7, 99
    s_cmp_ge_u32 s52, s47
    s_cselect_b32 s52, 3, s52
    s_cmp_ge_u32 s41, 124
    s_cselect_b32 s52, 3, s52
    s_cmp_eq_u32 s52, 3
    s_cbranch_scc1 L_ld_tail
    s_cmp_eq_u32 s52, 4
    s_cbranch_scc1 L_ld_w0
    s_cmp_eq_u32 s52, 5
    s_cbranch_scc1 L_ld_w1
    s_cmp_eq_u32 s52, 6
    s_cbranch_scc1 L_ld_w2
    s_cmp_eq_u32 s52, 7
    s_cbranch_scc1 L_ld_w3
    s_cmp_eq_u32 s52, 8
    s_cbranch_scc1 L_ld_w4
    s_add_u32 m0, s42, 0
    s_add_u32 s47, s46, 0
    s_waitcnt vmcnt(21)
    buffer_load_dwordx4 v20, s[8:11], s47 offen offset:0 nt lds
    s_waitcnt vmcnt(21)
    buffer_load_dwordx4 v21, s[8:11], s47 offen offset:1024 nt lds
    s_waitcnt vmcnt(21)
    buffer_load_dwordx4 v22, s[8:11], s47 offen offset:2048 nt lds
    s_waitcnt vmcnt(21)
    buffer_load_dwordx4 v23, s[8:11], s47 offen offset:3072 nt lds
    s_add_u32 m0, s42, 4096
    s_add_u32 s47, s46, 4096
    s_waitcnt vmcnt(21)
    buffer_load_dwordx4 v24, s[8:11], s47 offen offset:0 nt lds
    s_waitcnt vmcnt(21)
    buffer_load_dwordx4 v25, s[8:11], s47 offen offset:1024 nt lds
    s_waitcnt vmcnt(21)
    buffer_load_dwordx4 v20, s[8:11], s47 offen offset:2048 nt lds
    s_waitcnt vmcnt(21)
    buffer_load_dwordx4 v21, s[8:11], s47 offen offset:3072 nt lds
    s_add_u32 m0, s42, 8192
    s_add_u32 s47, s46, 8192
    s_waitcnt vmcnt(21)
    buffer_load_dwordx4 v22, s[8:11], s47 offen offset:0 nt lds
    s_waitcnt vmcnt(21)
    s_sub_u32 s48, s41, 0
    s_max_i32 s51, s51, s48
    v_mov_b32 v2, s51
    ds_write_b32 v1, v2 offset:0
    buffer_load_dwordx4 v23, s[8:11], s47 offen offset:1024 nt lds
    s_and_b32 s48, s41, 1
    s_xor_b32 s48, s48, 1
    s_lshl_b32 s48, s48, 2
    v_mov_b32 v4, s48
    ds_read_b32 v3, v4 offset:4
    ds_read_b32 v5, v1 offset:28
    s_waitcnt vmcnt(21)
    buffer_load_dwordx4 v24, s[8:11], s47 offen offset:2048 nt lds
    s_waitcnt vmcnt(21)
    buffer_load_dwordx4 v25, s[8:11], s47 offen offset:3072 nt lds
    s_branch L_ld_next
L_ld_tail:
    s_add_u32 m0, s42, 0
    s_add_u32 s47, s46, 0
    s_waitcnt vmcnt(39)
    buffer_load_dwordx4 v20, s[8:11], s47 offen offset:0 nt lds
    s_waitcnt vmcnt(39)
    buffer_load_dwordx4 v21, s[8:11], s47 offen offset:1024 nt lds
    s_waitcnt vmcnt(39)
    buffer_load_dwordx4 v22, s[8:11], s47 offen offset:2048 nt lds
    s_waitcnt vmcnt(39)
    s_sub_u32 s48, s41, 2
    s_max_i32 s51, s51, s48
    v_mov_b32 v2, s51
    ds_write_b32 v1, v2 offset:0
    buffer_load_dwordx4 v23, s[8:11], s47 offen offset:3072 nt lds
    s_add_u32 m0, s42, 4096
    s_add_u32 s47, s46, 4096
    s_waitcnt vmcnt(39)
    buffer_load_dwordx4 v24, s[8:11], s47 offen offset:0 nt lds
    s_waitcnt vmcnt(39)
    buffer_load_dwordx4 v25, s[8:11], s47 offen offset:1024 nt lds
    s_waitcnt vmcnt(39)
    buffer_load_dwordx4 v20, s[8:11], s47 offen offset:2048 nt lds
    s_waitcnt vmcnt(39)
    buffer_load_dwordx4 v21, s[8:11], s47 offen offset:3072 nt lds
    s_add_u32 m0, s42, 8192
    s_add_u32 s47, s46, 8192
    s_waitcnt vmcnt(39)
    buffer_load_dwordx4 v22, s[8:11], s47 offen offset:0 nt lds
    s_waitcnt vmcnt(39)
    buffer_load_dwordx4 v23, s[8:11], s47 offen offset:1024 nt lds
    s_and_b32 s48, s41, 1
    s_xor_b32 s48, s48, 1
    s_lshl_b32 s48, s48, 2
    v_mov_b32 v4, s48
    ds_read_b32 v3, v4 offset:4
    ds_read_b32 v5, v1 offset:28
    s_waitcnt vmcnt(39)
    buffer_load_dwordx4 v24, s[8:11], s47 offen offset:2048 nt lds
    s_waitcnt vmcnt(39)
    buffer_load_dwordx4 v25, s[8:11], s47 offen offset:3072 nt lds
    s_branch L_ld_next
L_ld_w0:
    s_add_u32 m0, s42, 0
    s_add_u32 s47, s46, 0
    s_waitcnt vmcnt(17)
    buffer_load_dwordx4 v20, s[8:11], s47 offen offset:0 nt lds
    s_waitcnt vmcnt(17)
    buffer_load_dwordx4 v21, s[8:11], s47 offen offset:1024 nt lds
    s_waitcnt vmcnt(17)
    buffer_load_dwordx4 v22, s[8:11], s47 offen offset:2048 nt lds
    s_waitcnt vmcnt(17)
    buffer_load_dwordx4 v23, s[8:11], s47 offen offset:3072 nt lds
    s_add_u32 m0, s42, 4096
    s_add_u32 s47, s46, 4096
    s_waitcnt vmcnt(17)
    buffer_load_dwordx4 v24, s[8:11], s47 offen offset:0 nt lds
    s_waitcnt vmcnt(17)
    s_sub_u32 s48, s41, 0
    s_max_i32 s51, s51, s48
    v_mov_b32 v2, s51
    ds_write_b32 v1, v2 offset:0
    buffer_load_dwordx4 v25, s[8:11], s47 offen offset:1024 nt lds
    s_waitcnt vmcnt(17)
    buffer_load_dwordx4 v20, s[8:11], s47 offen offset:2048 nt lds
    s_waitcnt vmcnt(17)
    buffer_load_dwordx4 v21, s[8:11], s47 offen offset:3072 nt lds
    s_add_u32 m0, s42, 8192
    s_add_u32 s47, s46, 8192
    s_waitcnt vmcnt(17)
    buffer_load_dwordx4 v22, s[8:11], s47 offen offset:0 nt lds
    s_waitcnt vmcnt(17)
    buffer_load_dwordx4 v23, s[8:11], s47 offen offset:1024 nt lds
    s_and_b32 s48, s41, 1
    s_xor_b32 s48, s48, 1
    s_lshl_b32 s48, s48, 2
    v_mov_b32 v4, s48
    ds_read_b32 v3, v4 offset:4
    ds_read_b32 v5, v1 offset:28
    s_waitcnt vmcnt(17)
    buffer_load_dwordx4 v24, s[8:11], s47 offen offset:2048 nt lds
    s_waitcnt vmcnt(17)
    buffer_load_dwordx4 v25, s[8:11], s47 offen offset:3072 nt lds
    s_branch L_ld_next
L_ld_w1:
    s_add_u32 m0, s42, 0
    s_add_u32 s47, s46, 0
    s_waitcnt vmcnt(19)
    buffer_load_dwordx4 v20, s[8:11], s47 offen offset:0 nt lds
    s_waitcnt vmcnt(19)
    buffer_load_dwordx4 v21, s[8:11], s47 offen offset:1024 nt lds
    s_waitcnt vmcnt(19)
    buffer_load_dwordx4 v22, s[8:11], s47 offen offset:2048 nt lds
    s_waitcnt vmcnt(19)
    buffer_load_dwordx4 v23, s[8:11], s47 offen offset:3072 nt lds
    s_add_u32 m0, s42, 4096
    s_add_u32 s47, s46, 4096
    s_waitcnt vmcnt(19)
    buffer_load_dwordx4 v24, s[8:11], s47 offen offset:0 nt lds
    s_waitcnt vmcnt(19)
    buffer_load_dwordx4 v25, s[8:11], s47 offen offset:1024 nt lds
    s_waitcnt vmcnt(19)
    buffer_load_dwordx4 v20, s[8:11], s47 offen offset:2048 nt lds
    s_waitcnt vmcnt(19)
    s_sub_u32 s48, s41, 0
    s_max_i32 s51, s51, s48
    v_mov_b32 v2, s51
    ds_write_b32 v1, v2 offset:0
    buffer_load_dwordx4 v21, s[8:11], s47 offen offset:3072 nt lds
    s_add_u32 m0, s42, 8192
    s_add_u32 s47, s46, 8192
    s_waitcnt vmcnt(19)
    buffer_load_dwordx4 v22, s[8:11], s47 offen offset:0 nt lds
    s_waitcnt vmcnt(19)
    buffer_load_dwordx4 v23, s[8:11], s47 offen offset:1024 nt lds
    s_and_b32 s48, s41, 1
    s_xor_b32 s48, s48, 1
    s_lshl_b32 s48, s48, 2
    v_mov_b32 v4, s48
    ds_read_b32 v3, v4 offset:4
    ds_read_b32 v5, v1 offset:28
    s_waitcnt vmcnt(19)
    buffer_load_dwordx4 v24, s[8:11], s47 offen offset:2048 nt lds
    s_waitcnt vmcnt(19)
    buffer_load_dwordx4 v25, s[8:11], s47 offen offset:3072 nt lds
    s_branch L_ld_next
L_ld_w2:
    s_add_u32 m0, s42, 0
    s_add_u32 s47, s46, 0
    s_waitcnt vmcnt(23)
    buffer_load_dwordx4 v20, s[8:11], s47 offen offset:0 nt lds
    s_waitcnt vmcnt(23)
    buffer_load_dwordx4 v21, s[8:11], s47 offen offset:1024 nt lds
    s_waitcnt vmcnt(23)
    buffer_load_dwordx4 v22, s[8:11], s47 offen offset:2048 nt lds
    s_waitcnt vmcnt(23)
    buffer_load_dwordx4 v23, s[8:11], s47 offen offset:3072 nt lds
    s_add_u32 m0, s42, 4096
    s_add_u32 s47, s46, 4096
    s_waitcnt vmcnt(23)
    buffer_load_dwordx4 v24, s[8:11], s47 offen offset:0 nt lds
    s_waitcnt vmcnt(23)
    buffer_load_dwordx4 v25, s[8:11], s47 offen offset:1024 nt lds
    s_waitcnt vmcnt(23)
    buffer_load_dwordx4 v20, s[8:11], s47 offen offset:2048 nt lds
    s_waitcnt vmcnt(23)
    buffer_load_dwordx4 v21, s[8:11], s47 offen offset:3072 nt lds
    s_add_u32 m0, s42, 8192
    s_add_u32 s47, s46, 8192
    s_waitcnt vmcnt(23)
    buffer_load_dwordx4 v22, s[8:11], s47 offen offset:0 nt lds
    s_waitcnt vmcnt(23)
    buffer_load_dwordx4 v23, s[8:11], s47 offen offset:1024 nt lds
    s_and_b32 s48, s41, 1
    s_xor_b32 s48, s48, 1
    s_lshl_b32 s48, s48, 2
    v_mov_b32 v4, s48
    ds_read_b32 v3, v4 offset:4
    ds_read_b32 v5, v1 offset:28
    s_waitcnt vmcnt(23)
    buffer_load_dwordx4 v24, s[8:11], s47 offen offset:2048 nt lds
    s_waitcnt vmcnt(23)
    s_sub_u32 s48, s41, 0
    s_max_i32 s51, s51, s48
    v_mov_b32 v2, s51
    ds_write_b32 v1, v2 offset:0
    buffer_load_dwordx4 v25, s[8:11], s47 offen offset:3072 nt lds
    s_branch L_ld_next
L_ld_w3:
    s_add_u32 m0, s42, 0
    s_add_u32 s47, s46, 0
    s_waitcnt vmcnt(26)
    buffer_load_dwordx4 v20, s[8:11], s47 offen offset:0 nt lds
    s_waitcnt vmcnt(26)
    buffer_load_dwordx4 v21, s[8:11], s47 offen offset:1024 nt lds
    s_waitcnt vmcnt(26)
    s_sub_u32 s48, s41, 1
    s_max_i32 s51, s51, s48
    v_mov_b32 v2, s51
    ds_write_b32 v1, v2 offset:0
    buffer_load_dwordx4 v22, s[8:11], s47 offen offset:2048 nt lds
    s_waitcnt vmcnt(26)
    buffer_load_dwordx4 v23, s[8:11], s47 offen offset:3072 nt lds
    s_add_u32 m0, s42, 4096
    s_add_u32 s47, s46, 4096
    s_waitcnt vmcnt(26)
    buffer_load_dwordx4 v24, s[8:11], s47 offen offset:0 nt lds
    s_waitcnt vmcnt(26)
    buffer_load_dwordx4 v25, s[8:11], s47 offen offset:1024 nt lds
    s_waitcnt vmcnt(26)
    buffer_load_dwordx4 v20, s[8:11], s47 offen offset:2048 nt lds
    s_waitcnt vmcnt(26)
    buffer_load_dwordx4 v21, s[8:11], s47 offen offset:3072 nt lds
    s_add_u32 m0, s42, 8192
    s_add_u32 s47, s46, 8192
    s_waitcnt vmcnt(26)
    buffer_load_dwordx4 v22, s[8:11], s47 offen offset:0 nt lds
    s_waitcnt vmcnt(26)
    buffer_load_dwordx4 v23, s[8:11], s47 offen offset:1024 nt lds
    s_and_b32 s48, s41, 1
    s_xor_b32 s48, s48, 1
    s_lshl_b32 s48, s48, 2
    v_mov_b32 v4, s48
    ds_read_b32 v3, v4 offset:4
    ds_read_b32 v5, v1 offset:28
    s_waitcnt vmcnt(26)
    buffer_load_dwordx4 v24, s[8:11], s47 offen offset:2048 nt lds
    s_waitcnt vmcnt(26)
    buffer_load_dwordx4 v25, s[8:11], s47 offen offset:3072 nt lds
    s_branch L_ld_next
L_ld_w4:
    s_add_u32 m0, s42, 0
    s_add_u32 s47, s46, 0
    s_waitcnt vmcnt(28)
    buffer_load_dwordx4 v20, s[8:11], s47 offen offset:0 nt lds
    s_waitcnt vmcnt(28)
    buffer_load_dwordx4 v21, s[8:11], s47 offen offset:1024 nt lds
    s_waitcnt vmcnt(28)
    buffer_load_dwordx4 v22, s[8:11], s47 offen offset:2048 nt lds
    s_waitcnt vmcnt(28)
    buffer_load_dwordx4 v23, s[8:11], s47 offen offset:3072 nt lds
    s_add_u32 m0, s42, 4096
    s_add_u32 s47, s46, 4096
    s_waitcnt vmcnt(28)
    s_sub_u32 s48, s41, 1
    s_max_i32 s51, s51, s48
    v_mov_b32 v2, s51
    ds_write_b32 v1, v2 offset:0
    buffer_load_dwordx4 v24, s[8:11], s47 offen offset:0 nt lds
    s_waitcnt vmcnt(28)
    buffer_load_dwordx4 v25, s[8:11], s47 offen offset:1024 nt lds
    s_waitcnt vmcnt(28)
    buffer_load_dwordx4 v20, s[8:11], s47 offen offset:2048 nt lds
    s_waitcnt vmcnt(28)
    buffer_load_dwordx4 v21, s[8:11], s47 offen offset:3072 nt lds
    s_add_u32 m0, s42, 8192
    s_add_u32 s47, s46, 8192
    s_waitcnt vmcnt(28)
    buffer_load_dwordx4 v22, s[8:11], s47 offen offset:0 nt lds
    s_waitcnt vmcnt(28)
    buffer_load_dwordx4 v23, s[8:11], s47 offen offset:1024 nt lds
    s_and_b32 s48, s41, 1
    s_xor_b32 s48, s48, 1
    s_lshl_b32 s48, s48, 2
    v_mov_b32 v4, s48
    ds_read_b32 v3, v4 offset:4
    ds_read_b32 v5, v1 offset:28
    s_waitcnt vmcnt(28)
    buffer_load_dwordx4 v24, s[8:11], s47 offen offset:2048 nt lds
    s_waitcnt vmcnt(28)
    buffer_load_dwordx4 v25, s[8:11], s47 offen offset:3072 nt lds
L_ld_next:
    s_add_u32 s42, s42, 12288
    s_cmp_ge_u32 s42, 163840
    s_cselect_b32 s42, 16384, s42
    s_add_u32 s41, s41, 1
    s_add_u32 s45, s45, 1
    s_cmp_lt_u32 s45, s61
    s_cbranch_scc1 L_ld_chunk
    s_add_u32 s43, s43, 1
    s_cmp_lt_u32 s43, 4
    s_cbranch_scc1 L_ld_phase
    s_max_i32 s51, s51, 124
    v_mov_b32 v2, s51
    s_waitcnt vmcnt(36)
    ds_write_b32 v1, v2 offset:0
    s_max_i32 s51, s51, 125
    v_mov_b32 v2, s51
    s_waitcnt vmcnt(24)
    ds_write_b32 v1, v2 offset:0
    s_max_i32 s51, s51, 126
    v_mov_b32 v2, s51
    s_waitcnt vmcnt(12)
    ds_write_b32 v1, v2 offset:0
    s_max_i32 s51, s51, 127
    v_mov_b32 v2, s51
    s_waitcnt vmcnt(0)
    ds_write_b32 v1, v2 offset:0
    s_endpgm
L_notloader:
    s_waitcnt lgkmcnt(0)
    s_load_dword s6, s[38:39], 0
    s_mov_b32 s12, s38
    s_mov_b32 s13, s39
    s_mov_b32 s14, 2097152
    s_mov_b32 s15, 0x20000
    s_cmp_eq_u32 s3, 3
    s_cbranch_scc1 L_aux
    s_sub_u32 s45, s3, 4
    s_cmp_lt_u32 s45, 8
    s_cbranch_scc1 L_stage1
    s_cmp_ge_u32 s3, 14
    s_cbranch_scc1 L_final
    s_cmp_ge_u32 s3, 4
    s_cbranch_scc1 L_hold_bar
    s_sub_u32 s40, s3, 1
    s_getpc_b64 s[58:59]
L_rtpc2:
    s_lshl_b32 s56, s4, 2
    s_add_u32 s56, s56, L_rtab-L_rtpc2
    s_load_dword s57, s[58:59], s56
    s_mov_b32 s8, s20
    s_mov_b32 s9, s21
    s_mov_b32 s10, 201326592
    s_mov_b32 s11, 0x20000
    s_waitcnt lgkmcnt(0)
    s_lshr_b32 s57, s57, 8
    s_add_u32 s56, s40, 30
    s_add_u32 s57, s57, s56
    s_and_b32 s57, s57, 31
    s_lshl_b32 s57, s57, 3
    s_add_u32 s56, s56, s5
    s_and_b32 s56, s56, 7
    s_add_u32 s57, s57, s56
    s_mul_i32 s57, s57, 12288
    s_mul_i32 s53, s4, 3145728
    s_add_u32 s53, s53, s57
    s_add_u32 s53, s53, 100663296
    s_add_u32 s54, s53, 6144
    v_and_b32 v8, 15, v0
    v_lshrrev_b32 v9, 4, v0
    v_lshrrev_b32 v10, 1, v8
    v_xor_b32 v10, v10, v9
    v_lshlrev_b32 v10, 4, v10
    v_mul_u32_u24 v4, 384, v8
    v_add_u32 v4, v4, v10
    v_mul_u32_u24 v5, 768, v9
    v_lshl_add_u32 v5, v8, 4, v5
    v_and_b32 v10, 1, v0
    v_lshlrev_b32 v10, 4, v10
    v_mov_b32 v11, 0xffff
    v_lshlrev_b32 v10, v10, v11
    v_bfe_u32 v11, v0, 1, 2
    v_cmp_eq_u32 vcc, 0, v11
    s_nop 1
    v_cndmask_b32 v100, 0, v10, vcc
    v_cmp_eq_u32 vcc, 1, v11
    s_nop 1
    v_cndmask_b32 v101, 0, v10, vcc
    v_cmp_eq_u32 vcc, 2, v11
    s_nop 1
    v_cndmask_b32 v102, 0, v10, vcc
    v_cmp_eq_u32 vcc, 3, v11
    s_nop 1
    v_cndmask_b32 v103, 0, v10, vcc
    s_lshl_b32 s47, s40, 2
    v_mov_b32 v3, s47
    s_waitcnt lgkmcnt(0)
    s_add_u32 s6, s6, 1
    s_mov_b32 s41, 0
    s_mul_i32 s42, s40, 12288
    s_add_u32 s42, s42, 16384
    s_add_u32 s43, s40, 2
    s_mov_b32 s44, 0
    s_mov_b32 s50, 0
L_c_seg:
    s_add_u32 s47, s41, 1
L_pl_5:
    ds_read_b32 v2, v1 offset:12
    s_waitcnt lgkmcnt(0)
    v_readfirstlane_b32 s46, v2
    s_cmp_ge_u32 s46, s47
    s_cbranch_scc1 L_pd_6
    s_sleep 2
    s_sub_u32 s7, s7, 1
    s_cbranch_scc0 L_pl_5
    s_endpgm
L_pd_6:
    s_mul_i32 s47, s41, 384
    v_lshrrev_b32 v9, 4, v0
    v_lshl_add_u32 v2, v9, 4, s47
    ds_read_b128 v[8:11], v2 offset:256
    ds_read_b128 v[12:15], v2 offset:320
    ds_read_b128 v[16:19], v2 offset:384
    ds_read_b128 v[20:23], v2 offset:448
    ds_read_b128 v[24:27], v2 offset:512
    ds_read_b128 v[28:31], v2 offset:576
    s_lshl_b32 s47, s40, 11
    s_add_u32 s47, s47, 4096
    v_and_b32 v6, 7, v0
    v_lshlrev_b32 v6, 4, v6
    v_bfe_u32 v7, v0, 3, 2
    v_lshl_add_u32 v6, v7, 2, v6
    v_add_u32 v6, s47, v6
    v_lshrrev_b32 v7, 3, v0
    v_lshl_add_u32 v7, v7, 4, s47
    v_mov_b32 v124, 0xff800000
    s_waitcnt lgkmcnt(0)
    s_mov_b32 s45, 0
L_c_k:
    s_cmp_ge_u32 s50, s43
    s_cbranch_scc1 L_pd_8
L_pl_7:
    ds_read_b32 v2, v1 offset:0
    s_waitcnt lgkmcnt(0)
    v_readfirstlane_b32 s50, v2
    s_cmp_ge_u32 s50, s43
    s_cbranch_scc1 L_pd_8
    s_sleep 1
    s_sub_u32 s7, s7, 1
    s_cbranch_scc0 L_pl_7
    s_endpgm
L_pd_8:
    v_add_u32 v125, s42, v4
    v_xor_b32 v126, 64, v125
    ds_read_b128 v[32:35], v125 offset:0
    ds_read_b128 v[36:39], v125 offset:6144
    ds_read_b128 v[40:43], v126 offset:0
    ds_read_b128 v[44:47], v126 offset:6144
    ds_read_b128 v[48:51], v125 offset:128
    ds_read_b128 v[52:55], v125 offset:6272
    ds_read_b128 v[56:59], v126 offset:128
    ds_read_b128 v[60:63], v126 offset:6272
    ds_read_b128 v[64:67], v125 offset:256
    ds_read_b128 v[68:71], v125 offset:6400
    ds_read_b128 v[72:75], v126 offset:256
    ds_read_b128 v[76:79], v126 offset:6400
    s_add_u32 s44, s44, 1
    v_mov_b32 v2, s44
    s_waitcnt lgkmcnt(11)
    v_mfma_f32_16x16x32_bf16 v[80:83], v[8:11], v[32:35], 0
    s_waitcnt lgkmcnt(10)
    v_mfma_f32_16x16x32_bf16 v[84:87], v[8:11], v[36:39], 0
    s_waitcnt lgkmcnt(9)
    v_mfma_f32_16x16x32_bf16 v[80:83], v[12:15], v[40:43], v[80:83]
    s_waitcnt lgkmcnt(8)
    v_mfma_f32_16x16x32_bf16 v[84:87], v[12:15], v[44:47], v[84:87]
    s_waitcnt lgkmcnt(7)
    v_mfma_f32_16x16x32_bf16 v[80:83], v[16:19], v[48:51], v[80:83]
    s_waitcnt lgkmcnt(6)
    v_mfma_f32_16x16x32_bf16 v[84:87], v[16:19], v[52:55], v[84:87]
    s_waitcnt lgkmcnt(5)
    v_mfma_f32_16x16x32_bf16 v[80:83], v[20:23], v[56:59], v[80:83]
    s_waitcnt lgkmcnt(4)
    v_mfma_f32_16x16x32_bf16 v[84:87], v[20:23], v[60:63], v[84:87]
    s_waitcnt lgkmcnt(3)
    v_mfma_f32_16x16x32_bf16 v[80:83], v[24:27], v[64:67], v[80:83]
    s_waitcnt lgkmcnt(2)
    v_mfma_f32_16x16x32_bf16 v[84:87], v[24:27], v[68:71], v[84:87]
    s_waitcnt lgkmcnt(1)
    v_mfma_f32_16x16x32_bf16 v[80:83], v[28:31], v[72:75], v[80:83]
    s_waitcnt lgkmcnt(0)
    v_mfma_f32_16x16x32_bf16 v[84:87], v[28:31], v[76:79], v[84:87]
    ds_write_b32 v3, v2 offset:4
    s_add_u32 s42, s42, 24576
    s_sub_u32 s47, s42, 147456
    s_cmp_ge_u32 s42, 163840
    s_cselect_b32 s42, s47, s42
    s_add_u32 s43, s43, 2
    s_add_u32 s45, s45, 1
    s_nop 0
    v_mov_b32_dpp v80, v84 quad_perm:[0,1,2,3] row_mask:0xa bank_mask:0xf
    v_cvt_pk_bf16_f32 v81, v80, v80
    v_and_b32 v81, 0xffff0000, v81
    v_mul_f32 v81, 0x3d93cd3a, v81
    v_cvt_pk_bf16_f32 v81, v81, v81
    v_and_b32 v81, 0xffff0000, v81
    v_max_f32 v124, v124, v81
    ds_write_b32 v6, v81
    v_add_u32 v6, 128, v6
    s_cmp_lt_u32 s45, 16
    s_cbranch_scc1 L_c_k
    s_lshl_b32 s47, s40, 11
    s_add_u32 s47, s47, 4096
    v_lshl_add_u32 v6, v0, 4, s47
    ds_read_b128 v[32:35], v6
    ds_read_b128 v[36:39], v6 offset:1024
    s_nop 1
    v_max_f32_dpp v124, v124, v124 quad_perm:[1,0,3,2] row_mask:0xf bank_mask:0xf
    s_nop 1
    v_max_f32_dpp v124, v124, v124 quad_perm:[2,3,0,1] row_mask:0xf bank_mask:0xf
    s_nop 1
    v_max_f32_dpp v124, v124, v124 row_half_mirror row_mask:0xf bank_mask:0xf
    s_nop 1
    v_max_f32_dpp v124, v124, v124 row_mirror row_mask:0xf bank_mask:0xf
    v_mov_b32 v2, v124
    s_nop 1
    v_permlane16_swap_b32 v124, v2
    v_max_f32 v124, v124, v2
    s_mov_b32 s47, 0x3fb8aa3b
    s_waitcnt lgkmcnt(0)
    v_sub_f32 v32, v32, v124
    v_sub_f32 v33, v33, v124
    v_sub_f32 v34, v34, v124
    v_sub_f32 v35, v35, v124
    v_sub_f32 v36, v36, v124
    v_sub_f32 v37, v37, v124
    v_sub_f32 v38, v38, v124
    v_sub_f32 v39, v39, v124
    v_mul_f32 v32, s47, v32
    v_mul_f32 v33, s47, v33
    v_mul_f32 v34, s47, v34
    v_mul_f32 v35, s47, v35
    v_mul_f32 v36, s47, v36
    v_mul_f32 v37, s47, v37
    v_mul_f32 v38, s47, v38
    v_mul_f32 v39, s47, v39
    v_exp_f32 v32, v32
    v_exp_f32 v33, v33
    v_exp_f32 v34, v34
    v_exp_f32 v35, v35
    v_exp_f32 v36, v36
    v_exp_f32 v37, v37
    v_exp_f32 v38, v38
    v_exp_f32 v39, v39
    v_add_f32 v40, v32, v33
    v_add_f32 v41, v34, v35
    v_add_f32 v42, v36, v37
    v_add_f32 v43, v38, v39
    v_add_f32 v40, v40, v41
    v_add_f32 v42, v42, v43
    v_add_f32 v45, v40, v42
    v_cvt_pk_bf16_f32 v32, v32, v32
    v_cvt_pk_bf16_f32 v33, v33, v33
    v_cvt_pk_bf16_f32 v34, v34, v34
    v_cvt_pk_bf16_f32 v35, v35, v35
    v_cvt_pk_bf16_f32 v36, v36, v36
    v_cvt_pk_bf16_f32 v37, v37, v37
    v_cvt_pk_bf16_f32 v38, v38, v38
    v_cvt_pk_bf16_f32 v39, v39, v39
    ds_write_b128 v6, v[32:35]
    ds_write_b128 v6, v[36:39] offset:1024
    s_nop 1
    v_add_f32_dpp v45, v45, v45 quad_perm:[1,0,3,2] row_mask:0xf bank_mask:0xf
    s_nop 1
    v_add_f32_dpp v45, v45, v45 quad_perm:[2,3,0,1] row_mask:0xf bank_mask:0xf
    s_nop 1
    v_add_f32_dpp v45, v45, v45 row_half_mirror row_mask:0xf bank_mask:0xf
    s_nop 1
    v_add_f32_dpp v45, v45, v45 row_mirror row_mask:0xf bank_mask:0xf
    v_mov_b32 v2, v45
    s_nop 1
    v_permlane16_swap_b32 v45, v2
    v_add_f32 v45, v45, v2
    v_mov_b32 v2, v45
    s_nop 1
    v_permlane32_swap_b32 v45, v2
    v_add_f32 v45, v45, v2
    v_mov_b32 v44, v124
    s_lshl_b32 s47, s41, 1
    s_add_u32 s47, s47, s40
    s_lshl_b32 s47, s47, 3
    v_mov_b32 v46, s47
    v_mov_b32 v47, 1
    s_mov_b64 exec, 1
    ds_write_b64 v46, v[44:45] offset:64
    ds_add_u32 v1, v47 offset:40
    s_mov_b64 exec, -1
    s_mul_i32 s47, s41, 1536
    s_mul_i32 s48, s40, 768
    s_add_u32 s47, s47, s48
    s_add_u32 s47, s47, 1024
    v_bfe_u32 v32, v0, 3, 1
    v_lshrrev_b32 v33, 4, v0
    v_and_b32 v34, 7, v0
    v_lshlrev_b32 v33, 5, v33
    v_lshl_add_u32 v33, v34, 2, v33
    v_add_u32 v33, s47, v33
    v_mul_u32_u24 v124, 448, v32
    v_add_u32 v124, v124, v33
    v_mul_u32_u24 v127, 192, v32
    v_add_u32 v127, v127, v33
    v_mov_b32 v126, 1
    v_mov_b32 v88, 0
    v_mov_b32 v89, 0
    v_mov_b32 v90, 0
    v_mov_b32 v91, 0
    v_mov_b32 v92, 0
    v_mov_b32 v93, 0
    v_mov_b32 v94, 0
    v_mov_b32 v95, 0
    v_mov_b32 v96, 0
    v_mov_b32 v97, 0
    v_mov_b32 v98, 0
    v_mov_b32 v99, 0
    s_mov_b32 s45, 0
    s_cmp_eq_u32 s41, 1
    s_cselect_b32 s51, 14, 99
    s_cselect_b32 s52, 15, 99
L_c_v:
    s_cmp_eq_u32 s45, s51
    s_cbranch_scc0 L_c_nodl
    buffer_load_dwordx4 v[8:11], v5, s[8:11], s53 offen offset:0 nt
    buffer_load_dwordx4 v[12:15], v5, s[8:11], s53 offen offset:256 nt
    buffer_load_dwordx4 v[16:19], v5, s[8:11], s53 offen offset:512 nt
    buffer_load_dwordx4 v[20:23], v5, s[8:11], s53 offen offset:3072 nt
    buffer_load_dwordx4 v[24:27], v5, s[8:11], s53 offen offset:3328 nt
    buffer_load_dwordx4 v[28:31], v5, s[8:11], s53 offen offset:3584 nt
    buffer_load_dwordx4 v[64:67], v5, s[8:11], s54 offen offset:0 nt
    buffer_load_dwordx4 v[68:71], v5, s[8:11], s54 offen offset:256 nt
    buffer_load_dwordx4 v[72:75], v5, s[8:11], s54 offen offset:512 nt
    buffer_load_dwordx4 v[76:79], v5, s[8:11], s54 offen offset:3072 nt
    buffer_load_dwordx4 v[80:83], v5, s[8:11], s54 offen offset:3328 nt
    buffer_load_dwordx4 v[84:87], v5, s[8:11], s54 offen offset:3584 nt
L_c_nodl:
    v_add_u32 v125, s42, v5
    ds_read_b128 v[120:123], v7
    v_add_u32 v7, 128, v7
    s_waitcnt lgkmcnt(0)
    v_and_b32 v104, v120, v100
    v_and_b32 v105, v120, v101
    v_and_b32 v106, v120, v102
    v_and_b32 v107, v120, v103
    v_and_b32 v108, v121, v100
    v_and_b32 v109, v121, v101
    v_and_b32 v110, v121, v102
    v_and_b32 v111, v121, v103
    v_and_b32 v112, v122, v100
    v_and_b32 v113, v122, v101
    v_and_b32 v114, v122, v102
    v_and_b32 v115, v122, v103
    v_and_b32 v116, v123, v100
    v_and_b32 v117, v123, v101
    v_and_b32 v118, v123, v102
    v_and_b32 v119, v123, v103
    s_cmp_eq_u32 s45, s52
    s_cbranch_scc1 L_c_dir
    s_cmp_ge_u32 s50, s43
    s_cbranch_scc1 L_pd_10
L_pl_9:
    ds_read_b32 v2, v1 offset:0
    s_waitcnt lgkmcnt(0)
    v_readfirstlane_b32 s50, v2
    s_cmp_ge_u32 s50, s43
    s_cbranch_scc1 L_pd_10
    s_sleep 1
    s_sub_u32 s7, s7, 1
    s_cbranch_scc0 L_pl_9
    s_endpgm
L_pd_10:
    ds_read_b128 v[32:35], v125 offset:0
    ds_read_b128 v[36:39], v125 offset:256
    ds_read_b128 v[40:43], v125 offset:512
    ds_read_b128 v[44:47], v125 offset:3072
    ds_read_b128 v[48:51], v125 offset:3328
    ds_read_b128 v[52:55], v125 offset:3584
    ds_read_b128 v[56:59], v125 offset:6144
    ds_read_b128 v[60:63], v125 offset:6400
    s_add_u32 s44, s44, 1
    v_mov_b32 v2, s44
    s_waitcnt lgkmcnt(7)
    v_mfma_f32_16x16x32_bf16 v[88:91], v[32:35], v[104:107], v[88:91]
    ds_read_b128 v[32:35], v125 offset:6656
    s_waitcnt lgkmcnt(7)
    v_mfma_f32_16x16x32_bf16 v[92:95], v[36:39], v[104:107], v[92:95]
    ds_read_b128 v[36:39], v125 offset:9216
    s_waitcnt lgkmcnt(7)
    v_mfma_f32_16x16x32_bf16 v[96:99], v[40:43], v[104:107], v[96:99]
    ds_read_b128 v[40:43], v125 offset:9472
    s_waitcnt lgkmcnt(7)
    v_mfma_f32_16x16x32_bf16 v[88:91], v[44:47], v[108:111], v[88:91]
    ds_read_b128 v[44:47], v125 offset:9728
    s_waitcnt lgkmcnt(7)
    v_mfma_f32_16x16x32_bf16 v[92:95], v[48:51], v[108:111], v[92:95]
    s_waitcnt lgkmcnt(6)
    v_mfma_f32_16x16x32_bf16 v[96:99], v[52:55], v[108:111], v[96:99]
    s_waitcnt lgkmcnt(5)
    v_mfma_f32_16x16x32_bf16 v[88:91], v[56:59], v[112:115], v[88:91]
    s_waitcnt lgkmcnt(4)
    v_mfma_f32_16x16x32_bf16 v[92:95], v[60:63], v[112:115], v[92:95]
    s_waitcnt lgkmcnt(3)
    v_mfma_f32_16x16x32_bf16 v[96:99], v[32:35], v[112:115], v[96:99]
    s_waitcnt lgkmcnt(2)
    v_mfma_f32_16x16x32_bf16 v[88:91], v[36:39], v[116:119], v[88:91]
    s_waitcnt lgkmcnt(1)
    v_mfma_f32_16x16x32_bf16 v[92:95], v[40:43], v[116:119], v[92:95]
    s_waitcnt lgkmcnt(0)
    v_mfma_f32_16x16x32_bf16 v[96:99], v[44:47], v[116:119], v[96:99]
    ds_write_b32 v3, v2 offset:4
    s_add_u32 s42, s42, 24576
    s_sub_u32 s47, s42, 147456
    s_cmp_ge_u32 s42, 163840
    s_cselect_b32 s42, s47, s42
    s_add_u32 s43, s43, 2
    s_add_u32 s45, s45, 1
    s_cmp_lt_u32 s45, 16
    s_cbranch_scc1 L_c_v
    s_branch L_c_vend
L_c_dir:
    s_waitcnt vmcnt(11)
    v_mfma_f32_16x16x32_bf16 v[88:91], v[8:11], v[104:107], v[88:91]
    s_waitcnt vmcnt(10)
    v_mfma_f32_16x16x32_bf16 v[92:95], v[12:15], v[104:107], v[92:95]
    s_waitcnt vmcnt(9)
    v_mfma_f32_16x16x32_bf16 v[96:99], v[16:19], v[104:107], v[96:99]
    s_waitcnt vmcnt(8)
    v_mfma_f32_16x16x32_bf16 v[88:91], v[20:23], v[108:111], v[88:91]
    s_waitcnt vmcnt(7)
    v_mfma_f32_16x16x32_bf16 v[92:95], v[24:27], v[108:111], v[92:95]
    s_waitcnt vmcnt(6)
    v_mfma_f32_16x16x32_bf16 v[96:99], v[28:31], v[108:111], v[96:99]
    s_waitcnt vmcnt(5)
    v_mfma_f32_16x16x32_bf16 v[88:91], v[64:67], v[112:115], v[88:91]
    s_waitcnt vmcnt(4)
    v_mfma_f32_16x16x32_bf16 v[92:95], v[68:71], v[112:115], v[92:95]
    s_waitcnt vmcnt(3)
    v_mfma_f32_16x16x32_bf16 v[96:99], v[72:75], v[112:115], v[96:99]
    s_waitcnt vmcnt(2)
    v_mfma_f32_16x16x32_bf16 v[88:91], v[76:79], v[116:119], v[88:91]
    s_waitcnt vmcnt(1)
    v_mfma_f32_16x16x32_bf16 v[92:95], v[80:83], v[116:119], v[92:95]
    s_waitcnt vmcnt(0)
    v_mfma_f32_16x16x32_bf16 v[96:99], v[84:87], v[116:119], v[96:99]
    s_nop 6
L_c_vend:
    v_cvt_pk_bf16_f32 v34, v92, v93
    v_cvt_pk_bf16_f32 v35, v94, v95
    v_mov_b32_dpp v88, v96 quad_perm:[0,1,2,3] row_mask:0xf bank_mask:0xc
    v_mov_b32_dpp v89, v97 quad_perm:[0,1,2,3] row_mask:0xf bank_mask:0xc
    v_mov_b32_dpp v90, v98 quad_perm:[0,1,2,3] row_mask:0xf bank_mask:0xc
    v_mov_b32_dpp v91, v99 quad_perm:[0,1,2,3] row_mask:0xf bank_mask:0xc
    v_cvt_pk_bf16_f32 v32, v88, v89
    v_cvt_pk_bf16_f32 v33, v90, v91
    ds_write2_b32 v124, v32, v33 offset0:0 offset1:48
    s_mov_b32 exec_lo, 0x00ff00ff
    s_mov_b32 exec_hi, 0xff00ff00
    ds_write2_b32 v127, v34, v35 offset0:32 offset1:80
    s_mov_b64 exec, 1
    ds_add_u32 v1, v126 offset:16
    s_mov_b64 exec, -1
    s_add_u32 s41, s41, 1
    s_cmp_lt_u32 s41, 2
    s_cbranch_scc1 L_c_seg
    s_endpgm
L_aux:
    s_cmp_eq_u32 s49, 2
    s_cbranch_scc1 L_a_noln
    v_lshrrev_b32 v2, 5, v0
    v_mul_u32_u24 v2, 1280, v2
    v_and_b32 v3, 31, v0
    v_lshl_add_u32 v40, v3, 4, v2
    v_lshl_add_u32 v41, v3, 3, v2
    v_add_u32 v42, 155648, v40
    v_add_u32 v43, 155648, v41
L_pl_11:
    ds_read_b32 v2, v1 offset:36
    s_waitcnt lgkmcnt(0)
    v_readfirstlane_b32 s46, v2
    s_cmp_ge_u32 s46, 1
    s_cbranch_scc1 L_pd_12
    s_sleep 1
    s_sub_u32 s7, s7, 1
    s_cbranch_scc0 L_pl_11
    s_endpgm
L_pd_12:
    ds_read_b128 v[4:7], v42
    ds_read_b128 v[8:11], v42 offset:512
    ds_read_b64 v[12:13], v43 offset:1024
    s_waitcnt lgkmcnt(0)
    v_lshlrev_b32 v64, 16, v4
    v_and_b32 v65, 0xffff0000, v4
    v_lshlrev_b32 v66, 16, v5
    v_and_b32 v67, 0xffff0000, v5
    v_lshlrev_b32 v68, 16, v6
    v_and_b32 v69, 0xffff0000, v6
    v_lshlrev_b32 v70, 16, v7
    v_and_b32 v71, 0xffff0000, v7
    v_lshlrev_b32 v72, 16, v8
    v_and_b32 v73, 0xffff0000, v8
    v_lshlrev_b32 v74, 16, v9
    v_and_b32 v75, 0xffff0000, v9
    v_lshlrev_b32 v76, 16, v10
    v_and_b32 v77, 0xffff0000, v10
    v_lshlrev_b32 v78, 16, v11
    v_and_b32 v79, 0xffff0000, v11
    v_lshlrev_b32 v80, 16, v12
    v_and_b32 v81, 0xffff0000, v12
    v_lshlrev_b32 v82, 16, v13
    v_and_b32 v83, 0xffff0000, v13
    v_add_f32 v4, v64, v65
    v_add_f32 v5, v66, v67
    v_add_f32 v6, v68, v69
    v_add_f32 v7, v70, v71
    v_add_f32 v8, v72, v73
    v_add_f32 v9, v74, v75
    v_add_f32 v10, v76, v77
    v_add_f32 v11, v78, v79
    v_add_f32 v12, v80, v81
    v_add_f32 v13, v82, v83
    v_add_f32 v4, v4, v9
    v_add_f32 v5, v5, v10
    v_add_f32 v6, v6, v11
    v_add_f32 v7, v7, v12
    v_add_f32 v8, v8, v13
    v_add_f32 v4, v4, v5
    v_add_f32 v6, v6, v7
    v_add_f32 v4, v4, v8
    v_add_f32 v4, v4, v6
    s_nop 1
    v_add_f32_dpp v4, v4, v4 quad_perm:[1,0,3,2] row_mask:0xf bank_mask:0xf
    s_nop 1
    v_add_f32_dpp v4, v4, v4 quad_perm:[2,3,0,1] row_mask:0xf bank_mask:0xf
    s_nop 1
    v_add_f32_dpp v4, v4, v4 row_half_mirror row_mask:0xf bank_mask:0xf
    s_nop 1
    v_add_f32_dpp v4, v4, v4 row_mirror row_mask:0xf bank_mask:0xf
    v_mov_b32 v5, v4
    s_nop 1
    v_permlane16_swap_b32 v4, v5
    v_add_f32 v4, v4, v5
    v_mul_f32 v4, 0x3acccccd, v4
    v_sub_f32 v44, v64, v4
    v_sub_f32 v45, v65, v4
    v_sub_f32 v46, v66, v4
    v_sub_f32 v47, v67, v4
    v_sub_f32 v48, v68, v4
    v_sub_f32 v49, v69, v4
    v_sub_f32 v50, v70, v4
    v_sub_f32 v51, v71, v4
    v_sub_f32 v52, v72, v4
    v_sub_f32 v53, v73, v4
    v_sub_f32 v54, v74, v4
    v_sub_f32 v55, v75, v4
    v_sub_f32 v56, v76, v4
    v_sub_f32 v57, v77, v4
    v_sub_f32 v58, v78, v4
    v_sub_f32 v59, v79, v4
    v_sub_f32 v60, v80, v4
    v_sub_f32 v61, v81, v4
    v_sub_f32 v62, v82, v4
    v_sub_f32 v63, v83, v4
    v_mul_f32 v6, v44, v44
    v_mul_f32 v7, v45, v45
    v_mul_f32 v8, v46, v46
    v_mul_f32 v9, v47, v47
    v_fmac_f32 v6, v48, v48
    v_fmac_f32 v7, v49, v49
    v_fmac_f32 v8, v50, v50
    v_fmac_f32 v9, v51, v51
    v_fmac_f32 v6, v52, v52
    v_fmac_f32 v7, v53, v53
    v_fmac_f32 v8, v54, v54
    v_fmac_f32 v9, v55, v55
    v_fmac_f32 v6, v56, v56
    v_fmac_f32 v7, v57, v57
    v_fmac_f32 v8, v58, v58
    v_fmac_f32 v9, v59, v59
    v_fmac_f32 v6, v60, v60
    v_fmac_f32 v7, v61, v61
    v_fmac_f32 v8, v62, v62
    v_fmac_f32 v9, v63, v63
    v_add_f32 v6, v6, v7
    v_add_f32 v8, v8, v9
    v_add_f32 v6, v6, v8
    v_cvt_pk_bf16_f32 v4, v4, v4
    v_and_b32 v4, 0xffff0000, v4
    v_add_f32_dpp v6, v6, v6 quad_perm:[1,0,3,2] row_mask:0xf bank_mask:0xf
    v_sub_f32 v64, v64, v4
    v_sub_f32 v65, v65, v4
    v_add_f32_dpp v6, v6, v6 quad_perm:[2,3,0,1] row_mask:0xf bank_mask:0xf
    v_sub_f32 v66, v66, v4
    v_sub_f32 v67, v67, v4
    v_add_f32_dpp v6, v6, v6 row_half_mirror row_mask:0xf bank_mask:0xf
    v_sub_f32 v68, v68, v4
    v_sub_f32 v69, v69, v4
    v_add_f32_dpp v6, v6, v6 row_mirror row_mask:0xf bank_mask:0xf
    v_sub_f32 v70, v70, v4
    v_sub_f32 v71, v71, v4
    v_mov_b32 v5, v6
    v_sub_f32 v72, v72, v4
    v_sub_f32 v73, v73, v4
    v_permlane16_swap_b32 v6, v5
    v_sub_f32 v74, v74, v4
    v_sub_f32 v75, v75, v4
    v_add_f32 v6, v6, v5
    v_sub_f32 v76, v76, v4
    v_sub_f32 v77, v77, v4
    v_mul_f32 v6, 0x3acccccd, v6
    v_sub_f32 v78, v78, v4
    v_sub_f32 v79, v79, v4
    v_cvt_pk_bf16_f32 v6, v6, v6
    v_sub_f32 v80, v80, v4
    v_sub_f32 v81, v81, v4
    v_and_b32 v6, 0xffff0000, v6
    v_sub_f32 v82, v82, v4
    v_sub_f32 v83, v83, v4
    v_add_f32 v6, 0x3727c5ac, v6
    v_cvt_pk_bf16_f32 v16, v64, v65
    v_cvt_pk_bf16_f32 v17, v66, v67
    v_cvt_pk_bf16_f32 v6, v6, v6
    v_cvt_pk_bf16_f32 v18, v68, v69
    v_cvt_pk_bf16_f32 v19, v70, v71
    v_and_b32 v6, 0xffff0000, v6
    v_cvt_pk_bf16_f32 v20, v72, v73
    v_cvt_pk_bf16_f32 v21, v74, v75
    v_sqrt_f32 v6, v6
    v_cvt_pk_bf16_f32 v22, v76, v77
    v_cvt_pk_bf16_f32 v23, v78, v79
    v_cvt_pk_bf16_f32 v6, v6, v6
    v_cvt_pk_bf16_f32 v24, v80, v81
    v_cvt_pk_bf16_f32 v25, v82, v83
    v_and_b32 v6, 0xffff0000, v6
    v_lshlrev_b32 v64, 16, v16
    v_and_b32 v65, 0xffff0000, v16
    v_rcp_f32 v6, v6
    v_lshlrev_b32 v66, 16, v17
    v_and_b32 v67, 0xffff0000, v17
    v_lshlrev_b32 v68, 16, v18
    v_and_b32 v69, 0xffff0000, v18
    v_lshlrev_b32 v70, 16, v19
    v_and_b32 v71, 0xffff0000, v19
    v_lshlrev_b32 v72, 16, v20
    v_and_b32 v73, 0xffff0000, v20
    v_lshlrev_b32 v74, 16, v21
    v_and_b32 v75, 0xffff0000, v21
    v_lshlrev_b32 v76, 16, v22
    v_and_b32 v77, 0xffff0000, v22
    v_lshlrev_b32 v78, 16, v23
    v_and_b32 v79, 0xffff0000, v23
    v_lshlrev_b32 v80, 16, v24
    v_and_b32 v81, 0xffff0000, v24
    v_lshlrev_b32 v82, 16, v25
    v_and_b32 v83, 0xffff0000, v25
    v_mul_f32 v64, v64, v6
    v_mul_f32 v65, v65, v6
    v_mul_f32 v66, v66, v6
    v_mul_f32 v67, v67, v6
    v_mul_f32 v68, v68, v6
    v_mul_f32 v69, v69, v6
    v_mul_f32 v70, v70, v6
    v_mul_f32 v71, v71, v6
    v_mul_f32 v72, v72, v6
    v_mul_f32 v73, v73, v6
    v_mul_f32 v74, v74, v6
    v_mul_f32 v75, v75, v6
    v_mul_f32 v76, v76, v6
    v_mul_f32 v77, v77, v6
    v_mul_f32 v78, v78, v6
    v_mul_f32 v79, v79, v6
    v_mul_f32 v80, v80, v6
    v_mul_f32 v81, v81, v6
    v_mul_f32 v82, v82, v6
    v_mul_f32 v83, v83, v6
    v_cvt_pk_bf16_f32 v16, v64, v65
    v_cvt_pk_bf16_f32 v17, v66, v67
    v_cvt_pk_bf16_f32 v18, v68, v69
    v_cvt_pk_bf16_f32 v19, v70, v71
    v_cvt_pk_bf16_f32 v20, v72, v73
    v_cvt_pk_bf16_f32 v21, v74, v75
    v_cvt_pk_bf16_f32 v22, v76, v77
    v_cvt_pk_bf16_f32 v23, v78, v79
    v_cvt_pk_bf16_f32 v24, v80, v81
    v_cvt_pk_bf16_f32 v25, v82, v83
    ds_write_b128 v40, v[16:19] offset:13312
    ds_write_b128 v40, v[20:23] offset:13824
    ds_write_b64 v41, v[24:25] offset:14336
    v_mov_b32 v2, 1
    s_waitcnt lgkmcnt(0)
    ds_write_b32 v1, v2 offset:32
L_a_noln:
    s_mov_b32 s8, s32
    s_mov_b32 s9, s33
    s_mov_b32 s10, 1966080
    s_mov_b32 s11, 0x20000
L_pl_13:
    ds_read_b32 v2, v1 offset:112
    s_waitcnt lgkmcnt(0)
    v_readfirstlane_b32 s46, v2
    s_cmp_ge_u32 s46, 1
    s_cbranch_scc1 L_pd_14
    s_sleep 2
    s_sub_u32 s7, s7, 1
    s_cbranch_scc0 L_pl_13
    s_endpgm
L_pd_14:
    v_and_b32 v4, 15, v0
    v_lshrrev_b32 v9, 4, v0
    v_mul_u32_u24 v5, 1280, v9
    v_lshl_add_u32 v5, v4, 4, v5
    v_lshlrev_b32 v6, 30, v9
    v_and_b32 v6, 0x80000000, v6
    v_or_b32 v6, v6, v5
    s_lshl_b32 s42, s4, 3
    s_add_u32 s42, s42, s5
    s_mul_i32 s43, s42, 7680
    s_add_u32 s44, s43, 5120
    buffer_load_dwordx4 v[40:43], v5, s[8:11], s43 offen offset:0 nt
    buffer_load_dwordx4 v[44:47], v5, s[8:11], s43 offen offset:256 nt
    buffer_load_dwordx4 v[48:51], v5, s[8:11], s43 offen offset:512 nt
    buffer_load_dwordx4 v[52:55], v5, s[8:11], s43 offen offset:768 nt
    buffer_load_dwordx4 v[56:59], v5, s[8:11], s43 offen offset:1024 nt
    buffer_load_dwordx4 v[60:63], v6, s[8:11], s44 offen offset:0 nt
    buffer_load_dwordx4 v[64:67], v6, s[8:11], s44 offen offset:256 nt
    buffer_load_dwordx4 v[68:71], v6, s[8:11], s44 offen offset:512 nt
    buffer_load_dwordx4 v[72:75], v6, s[8:11], s44 offen offset:768 nt
    buffer_load_dwordx4 v[76:79], v6, s[8:11], s44 offen offset:1024 nt
    v_lshlrev_b32 v5, 4, v0
    v_bfe_u32 v6, v0, 3, 1
    v_mul_u32_u24 v6, 384, v6
    v_bfe_u32 v7, v0, 4, 1
    v_lshl_add_u32 v6, v7, 6, v6
    v_and_b32 v7, 7, v0
    v_lshl_add_u32 v6, v7, 1, v6
    s_lshl_b32 s42, s4, 12
    s_add_u32 s42, s42, 32768
    v_and_b32 v10, 1, v0
    v_lshlrev_b32 v10, 4, v10
    v_mov_b32 v11, 0xffff
    v_lshlrev_b32 v10, v10, v11
    v_bfe_u32 v11, v0, 1, 2
    v_cmp_eq_u32 vcc, 0, v11
    s_nop 1
    v_cndmask_b32 v100, 0, v10, vcc
    v_cmp_eq_u32 vcc, 1, v11
    s_nop 1
    v_cndmask_b32 v101, 0, v10, vcc
    v_cmp_eq_u32 vcc, 2, v11
    s_nop 1
    v_cndmask_b32 v102, 0, v10, vcc
    v_cmp_eq_u32 vcc, 3, v11
    s_nop 1
    v_cndmask_b32 v103, 0, v10, vcc
    s_waitcnt lgkmcnt(0)
    s_add_u32 s6, s6, 1
    s_cmp_eq_u32 s54, 20
    s_cselect_b32 s43, 5, 3
L_pl_15:
    ds_read_b32 v2, v1 offset:0
    s_waitcnt lgkmcnt(0)
    v_readfirstlane_b32 s46, v2
    s_cmp_ge_u32 s46, s43
    s_cbranch_scc1 L_pd_16
    s_sleep 2
    s_sub_u32 s7, s7, 1
    s_cbranch_scc0 L_pl_15
    s_endpgm
L_pd_16:
L_a_q:
L_g_17:
    buffer_load_dwordx4 v[8:11], v5, s[12:15], s42 offen offset:0 sc1
    buffer_load_dwordx4 v[12:15], v5, s[12:15], s42 offen offset:1024 sc1
    buffer_load_dwordx4 v[16:19], v5, s[12:15], s42 offen offset:2048 sc1
L_gc_20:
    v_mov_b32 v3, 0
    s_waitcnt vmcnt(0)
    v_bitop3_b32 v3, v3, v8, s6 bitop3:0xf6
    v_bitop3_b32 v3, v3, v9, s6 bitop3:0xf6
    v_bitop3_b32 v3, v3, v10, s6 bitop3:0xf6
    v_bitop3_b32 v3, v3, v11, s6 bitop3:0xf6
    v_bitop3_b32 v3, v3, v12, s6 bitop3:0xf6
    v_bitop3_b32 v3, v3, v13, s6 bitop3:0xf6
    v_bitop3_b32 v3, v3, v14, s6 bitop3:0xf6
    v_bitop3_b32 v3, v3, v15, s6 bitop3:0xf6
    v_bitop3_b32 v3, v3, v16, s6 bitop3:0xf6
    v_bitop3_b32 v3, v3, v17, s6 bitop3:0xf6
    v_bitop3_b32 v3, v3, v18, s6 bitop3:0xf6
    v_bitop3_b32 v3, v3, v19, s6 bitop3:0xf6
    v_and_b32 v3, 0x7, v3
    v_cmp_ne_u32 vcc, 0, v3
    s_cbranch_vccz L_gok_18
    s_sleep 12
    s_sub_u32 s7, s7, 1
    s_cbranch_scc0 L_g_17
    s_endpgm
L_gok_18:
    v_and_b32 v8, -8, v8
    v_and_b32 v9, -8, v9
    v_and_b32 v10, -8, v10
    v_and_b32 v11, -8, v11
    v_and_b32 v12, -8, v12
    v_and_b32 v13, -8, v13
    v_and_b32 v14, -8, v14
    v_and_b32 v15, -8, v15
    v_and_b32 v16, -8, v16
    v_and_b32 v17, -8, v17
    v_and_b32 v18, -8, v18
    v_and_b32 v19, -8, v19
    v_mov_b32 v24, v8
    v_mov_b32 v25, v9
    v_mov_b32 v26, v10
    v_mov_b32 v27, v11
    v_mov_b32 v28, v12
    v_mov_b32 v29, v13
    v_mov_b32 v30, v14
    v_mov_b32 v31, v15
    v_mov_b32 v32, v16
    v_mov_b32 v33, v17
    v_mov_b32 v34, v18
    v_mov_b32 v35, v19
    v_permlane32_swap_b32 v8, v24
    v_permlane32_swap_b32 v9, v25
    v_permlane32_swap_b32 v10, v26
    v_permlane32_swap_b32 v11, v27
    v_permlane32_swap_b32 v12, v28
    v_permlane32_swap_b32 v13, v29
    v_permlane32_swap_b32 v14, v30
    v_permlane32_swap_b32 v15, v31
    v_permlane32_swap_b32 v16, v32
    v_permlane32_swap_b32 v17, v33
    v_permlane32_swap_b32 v18, v34
    v_permlane32_swap_b32 v19, v35
    v_add_f32 v8, v8, v24
    v_add_f32 v9, v9, v25
    v_add_f32 v10, v10, v26
    v_add_f32 v11, v11, v27
    v_add_f32 v12, v12, v28
    v_add_f32 v13, v13, v29
    v_add_f32 v14, v14, v30
    v_add_f32 v15, v15, v31
    v_add_f32 v16, v16, v32
    v_add_f32 v17, v17, v33
    v_add_f32 v18, v18, v34
    v_add_f32 v19, v19, v35
    v_cvt_pk_bf16_f32 v24, v8, v9
    v_cvt_pk_bf16_f32 v25, v10, v11
    v_cvt_pk_bf16_f32 v26, v12, v13
    v_cvt_pk_bf16_f32 v27, v14, v15
    v_cvt_pk_bf16_f32 v28, v16, v17
    v_cvt_pk_bf16_f32 v29, v18, v19
    ds_write_b16 v6, v24 offset:256
    ds_write_b16_d16_hi v6, v24 offset:272
    ds_write_b16 v6, v25 offset:288
    ds_write_b16_d16_hi v6, v25 offset:304
    ds_write_b16 v6, v26 offset:384
    ds_write_b16_d16_hi v6, v26 offset:400
    ds_write_b16 v6, v27 offset:416
    ds_write_b16_d16_hi v6, v27 offset:432
    ds_write_b16 v6, v28 offset:512
    ds_write_b16_d16_hi v6, v28 offset:528
    ds_write_b16 v6, v29 offset:544
    ds_write_b16_d16_hi v6, v29 offset:560
    v_mov_b32 v2, 2
    ds_write_b32 v1, v2 offset:12
L_pl_21:
    ds_read_b32 v2, v1 offset:0
    s_waitcnt lgkmcnt(0)
    v_readfirstlane_b32 s46, v2
    s_cmp_ge_u32 s46, 10
    s_cbranch_scc1 L_pd_22
    s_sleep 16
    s_sub_u32 s7, s7, 1
    s_cbranch_scc0 L_pl_21
    s_endpgm
L_pd_22:
    v_lshrrev_b32 v9, 4, v0
    v_bfe_u32 v4, v0, 1, 1
    v_lshl_add_u32 v4, v4, 2, v9
    v_min_u32 v4, 5, v4
    s_and_b32 s45, s4, 3
    s_lshl_b32 s45, s45, 3
    s_add_u32 s45, s45, s5
    s_mul_i32 s45, s45, 6
    v_add_u32 v4, s45, v4
    v_bfe_u32 v5, v4, 5, 1
    v_lshlrev_b32 v5, 4, v5
    v_and_b32 v6, 8, v0
    v_add_u32 v5, v5, v6
    v_and_b32 v6, 7, v4
    v_add_u32 v5, v5, v6
    v_lshlrev_b32 v5, 4, v5
    v_and_b32 v6, 1, v0
    v_lshl_add_u32 v5, v6, 9, v5
    v_lshrrev_b32 v6, 6, v4
    v_lshl_add_u32 v5, v6, 12, v5
    v_bfe_u32 v7, v4, 3, 2
    s_and_b32 s42, s4, 28
    s_lshl_b32 s42, s42, 12
    s_add_u32 s42, s42, 35840
L_g_23:
    buffer_load_dwordx4 v[8:11], v5, s[12:15], s42 offen offset:0 sc1
L_gc_26:
    v_mov_b32 v3, 0
    s_waitcnt vmcnt(0)
    v_bitop3_b32 v3, v3, v8, s6 bitop3:0xf6
    v_bitop3_b32 v3, v3, v9, s6 bitop3:0xf6
    v_bitop3_b32 v3, v3, v10, s6 bitop3:0xf6
    v_bitop3_b32 v3, v3, v11, s6 bitop3:0xf6
    v_and_b32 v3, 0xff, v3
    v_cmp_ne_u32 vcc, 0, v3
    s_cbranch_vccz L_gok_24
    s_sleep 12
    s_sub_u32 s7, s7, 1
    s_cbranch_scc0 L_g_23
    s_endpgm
L_gok_24:
    v_and_b32 v8, 0xffffff00, v8
    v_and_b32 v9, 0xffffff00, v9
    v_and_b32 v10, 0xffffff00, v10
    v_and_b32 v11, 0xffffff00, v11
    s_cmp_eq_u32 s49, 2
    s_cbranch_scc1 L_a_rsok
L_pl_27:
    ds_read_b32 v2, v1 offset:52
    s_waitcnt lgkmcnt(0)
    v_readfirstlane_b32 s46, v2
    s_cmp_ge_u32 s46, 1
    s_cbranch_scc1 L_pd_28
    s_sleep 8
    s_sub_u32 s7, s7, 1
    s_cbranch_scc0 L_pl_27
    s_endpgm
L_pd_28:
L_a_rsok:
    v_cmp_eq_u32 vcc, 1, v7
    s_nop 1
    v_cndmask_b32 v8, v8, v9, vcc
    v_cmp_eq_u32 vcc, 2, v7
    s_nop 1
    v_cndmask_b32 v8, v8, v10, vcc
    v_cmp_eq_u32 vcc, 3, v7
    s_nop 1
    v_cndmask_b32 v8, v8, v11, vcc
    v_cvt_pk_bf16_f32 v8, v8, v8
    v_and_b32 v8, 0xffff0000, v8
    v_mul_f32 v9, 0xbfb8aa3b, v8
    v_exp_f32 v9, v9
    s_nop 0
    v_add_f32 v9, 1.0, v9
    v_rcp_f32 v9, v9
    s_nop 0
    v_cvt_pk_bf16_f32 v9, v9, v9
    v_and_b32 v9, 0xffff0000, v9
    s_nop 1
    v_mov_b32_dpp v10, v9 quad_perm:[0,0,0,0] row_mask:0xf bank_mask:0xf
    v_mov_b32_dpp v11, v9 quad_perm:[2,2,2,2] row_mask:0xf bank_mask:0xf
    s_nop 0
    v_mul_f32_dpp v10, v8, v10 quad_perm:[1,1,1,1] row_mask:0xf bank_mask:0xf
    v_mul_f32_dpp v11, v8, v11 quad_perm:[3,3,3,3] row_mask:0xf bank_mask:0xf
    v_cvt_pk_bf16_f32 v10, v10, v10
    v_cvt_pk_bf16_f32 v11, v11, v11
    v_cmp_gt_u32 vcc, 32, v0
    s_nop 1
    v_cndmask_b32 v11, 0, v11, vcc
    v_and_b32 v12, v10, v100
    v_and_b32 v16, v11, v100
    v_and_b32 v13, v10, v101
    v_and_b32 v17, v11, v101
    v_and_b32 v14, v10, v102
    v_and_b32 v18, v11, v102
    v_and_b32 v15, v10, v103
    v_and_b32 v19, v11, v103
    s_waitcnt vmcnt(0)
    v_mfma_f32_16x16x32_bf16 v[80:83], v[40:43], v[12:15], 0
    v_mfma_f32_16x16x32_bf16 v[84:87], v[44:47], v[12:15], 0
    v_mfma_f32_16x16x32_bf16 v[88:91], v[48:51], v[12:15], 0
    v_mfma_f32_16x16x32_bf16 v[92:95], v[52:55], v[12:15], 0
    v_mfma_f32_16x16x32_bf16 v[96:99], v[56:59], v[12:15], 0
    v_mfma_f32_16x16x32_bf16 v[80:83], v[60:63], v[16:19], v[80:83]
    v_mfma_f32_16x16x32_bf16 v[84:87], v[64:67], v[16:19], v[84:87]
    v_mfma_f32_16x16x32_bf16 v[88:91], v[68:71], v[16:19], v[88:91]
    v_mfma_f32_16x16x32_bf16 v[92:95], v[72:75], v[16:19], v[92:95]
    v_mfma_f32_16x16x32_bf16 v[96:99], v[76:79], v[16:19], v[96:99]
    v_bfe_u32 v4, v0, 3, 1
    v_mul_u32_u24 v4, 2560, v4
    v_lshrrev_b32 v5, 5, v0
    v_lshl_add_u32 v4, v5, 8, v4
    v_and_b32 v5, 7, v0
    v_lshl_add_u32 v4, v5, 4, v4
    v_bfe_u32 v5, v0, 4, 1
    v_lshl_add_u32 v4, v5, 3, v4
    v_add_u32 v4, 8192, v4
    v_mul_f32 v80, 0.5, v80
    v_mul_f32 v81, 0.5, v81
    v_mul_f32 v82, 0.5, v82
    v_mul_f32 v83, 0.5, v83
    v_mul_f32 v84, 0.5, v84
    v_mul_f32 v85, 0.5, v85
    v_mul_f32 v86, 0.5, v86
    v_mul_f32 v87, 0.5, v87
    v_mul_f32 v88, 0.5, v88
    v_mul_f32 v89, 0.5, v89
    v_mul_f32 v90, 0.5, v90
    v_mul_f32 v91, 0.5, v91
    v_mul_f32 v92, 0.5, v92
    v_mul_f32 v93, 0.5, v93
    v_mul_f32 v94, 0.5, v94
    v_mul_f32 v95, 0.5, v95
    v_mul_f32 v96, 0.5, v96
    v_mul_f32 v97, 0.5, v97
    v_mul_f32 v98, 0.5, v98
    v_mul_f32 v99, 0.5, v99
    ds_write2_b32 v4, v80, v82 offset0:0 offset1:1
    ds_write2_b32 v4, v81, v83 offset0:32 offset1:33
    v_add_u32 v4, 512, v4
    ds_write2_b32 v4, v84, v86 offset0:0 offset1:1
    ds_write2_b32 v4, v85, v87 offset0:32 offset1:33
    v_add_u32 v4, 512, v4
    ds_write2_b32 v4, v88, v90 offset0:0 offset1:1
    ds_write2_b32 v4, v89, v91 offset0:32 offset1:33
    v_add_u32 v4, 512, v4
    ds_write2_b32 v4, v92, v94 offset0:0 offset1:1
    ds_write2_b32 v4, v93, v95 offset0:32 offset1:33
    v_add_u32 v4, 512, v4
    ds_write2_b32 v4, v96, v98 offset0:0 offset1:1
    ds_write2_b32 v4, v97, v99 offset0:32 offset1:33
L_a_gend:
    v_mov_b32 v2, 1
    s_waitcnt lgkmcnt(0)
    ds_write_b32 v1, v2 offset:20
L_pl_29:
    ds_read_b32 v2, v1 offset:0
    s_waitcnt lgkmcnt(0)
    v_readfirstlane_b32 s46, v2
    s_cmp_ge_u32 s46, 94
    s_cbranch_scc1 L_pd_30
    s_sleep 32
    s_sub_u32 s7, s7, 1
    s_cbranch_scc0 L_pl_29
    s_endpgm
L_pd_30:
L_pl_31:
    ds_read_b32 v2, v1 offset:40
    s_waitcnt lgkmcnt(0)
    v_readfirstlane_b32 s46, v2
    s_cmp_ge_u32 s46, 4
    s_cbranch_scc1 L_pd_32
    s_sleep 8
    s_sub_u32 s7, s7, 1
    s_cbranch_scc0 L_pl_31
    s_endpgm
L_pd_32:
    v_and_b32 v4, 3, v0
    v_lshlrev_b32 v5, 3, v4
    v_lshlrev_b32 v4, 4, v4
    ds_read_b64 v[8:9], v5 offset:64
    v_mov_b32 v10, s6
    v_mov_b32 v11, s6
    s_lshl_b32 s42, s4, 9
    s_add_u32 s42, s42, 4096
    s_lshl_b32 s43, s5, 6
    s_add_u32 s43, s43, s42
    s_mov_b64 exec, 15
    s_waitcnt lgkmcnt(0)
    buffer_store_dwordx4 v[8:11], v4, s[12:15], s43 offen sc1
    s_mov_b64 exec, -1
    v_bfe_u32 v6, v0, 1, 3
    v_lshlrev_b32 v4, 6, v6
    v_bfe_u32 v5, v0, 4, 1
    v_lshlrev_b32 v5, 1, v5
    v_and_b32 v7, 1, v0
    v_add_u32 v5, v5, v7
    v_lshl_add_u32 v4, v5, 4, v4
    v_lshlrev_b32 v5, 2, v5
L_pl_33:
    ds_read_b32 v2, v1 offset:0
    s_waitcnt lgkmcnt(0)
    v_readfirstlane_b32 s46, v2
    s_cmp_ge_u32 s46, 112
    s_cbranch_scc1 L_pd_34
    s_sleep 16
    s_sub_u32 s7, s7, 1
    s_cbranch_scc0 L_pl_33
    s_endpgm
L_pd_34:
L_a_ml:
    buffer_load_dwordx4 v[12:15], v4, s[12:15], s42 offen sc1
    s_waitcnt vmcnt(0)
    v_cmp_ne_u32 vcc, s6, v14
    v_cmp_ne_u32 s[52:53], s6, v15
    s_or_b64 vcc, vcc, s[52:53]
    s_cbranch_scc0 L_a_mlok
    s_sleep 8
    s_sub_u32 s7, s7, 1
    s_cbranch_scc0 L_a_ml
    s_endpgm
L_a_mlok:
    v_mov_b32 v16, v12
    s_nop 1
    v_max_f32_dpp v16, v16, v16 quad_perm:[1,0,3,2] row_mask:0xf bank_mask:0xf
    s_nop 1
    v_max_f32_dpp v16, v16, v16 quad_perm:[2,3,0,1] row_mask:0xf bank_mask:0xf
    s_nop 1
    v_max_f32_dpp v16, v16, v16 row_half_mirror row_mask:0xf bank_mask:0xf
    s_nop 1
    v_max_f32_dpp v16, v16, v16 row_mirror row_mask:0xf bank_mask:0xf
    v_sub_f32 v12, v12, v16
    v_mul_f32 v12, 0x3fb8aa3b, v12
    v_exp_f32 v12, v12
    s_nop 0
    v_mul_f32 v13, v13, v12
    s_nop 1
    v_add_f32_dpp v13, v13, v13 quad_perm:[1,0,3,2] row_mask:0xf bank_mask:0xf
    s_nop 1
    v_add_f32_dpp v13, v13, v13 quad_perm:[2,3,0,1] row_mask:0xf bank_mask:0xf
    s_nop 1
    v_add_f32_dpp v13, v13, v13 row_half_mirror row_mask:0xf bank_mask:0xf
    s_nop 1
    v_add_f32_dpp v13, v13, v13 row_mirror row_mask:0xf bank_mask:0xf
    v_rcp_f32 v13, v13
    v_cmp_eq_u32 vcc, s5, v6
    v_mul_f32 v12, v12, v13
    v_mov_b32 v2, 1
    s_mov_b64 exec, vcc
    ds_write_b32 v5, v12 offset:96
    ds_write_b32 v1, v2 offset:44
    s_endpgm
L_stage1:
    s_cmp_eq_u32 s49, 2
    s_cbranch_scc1 L_hold_bar
    v_and_b32 v2, 1, v0
    v_lshlrev_b32 v2, 4, v2
    v_mov_b32 v3, 0xffff
    v_lshlrev_b32 v2, v2, v3
    v_bfe_u32 v3, v0, 1, 2
    v_cmp_eq_u32 vcc, 0, v3
    s_nop 1
    v_cndmask_b32 v92, 0, v2, vcc
    v_cmp_eq_u32 vcc, 1, v3
    s_nop 1
    v_cndmask_b32 v93, 0, v2, vcc
    v_cmp_eq_u32 vcc, 2, v3
    s_nop 1
    v_cndmask_b32 v94, 0, v2, vcc
    v_cmp_eq_u32 vcc, 3, v3
    s_nop 1
    v_cndmask_b32 v95, 0, v2, vcc
    v_mov_b32 v2, 0x0c0c0c0c
    s_mov_b32 s46, 0x01000100
    s_mov_b32 s47, 0x03020302
    v_bfi_b32 v84, v92, s46, v2
    v_bfi_b32 v88, v92, s47, v2
    v_bfi_b32 v85, v93, s46, v2
    v_bfi_b32 v89, v93, s47, v2
    v_bfi_b32 v86, v94, s46, v2
    v_bfi_b32 v90, v94, s47, v2
    v_bfi_b32 v87, v95, s46, v2
    v_bfi_b32 v91, v95, s47, v2
    s_and_b32 s44, s5, 1
    s_cmp_eq_u32 s49, 0
    s_cselect_b32 s44, s44, 0
    s_mul_i32 s44, s44, 640
    s_mul_i32 s46, s45, 80
    s_add_u32 s44, s44, s46
    s_add_u32 s44, s44, 13312
    v_bfe_u32 v4, v0, 3, 1
    v_mul_u32_u24 v4, 1280, v4
    v_lshrrev_b32 v3, 4, v0
    v_lshl_add_u32 v4, v3, 2, v4
    v_add_u32 v4, s44, v4
    s_mul_i32 s44, s45, 5120
    s_add_u32 s44, s44, 114688
    v_lshl_add_u32 v5, v0, 4, s44
    s_lshl_b32 s44, s45, 9
    v_lshl_add_u32 v6, v0, 4, s44
    v_and_b32 v7, 31, v0
    v_lshlrev_b32 v7, 4, v7
    v_lshrrev_b32 v3, 5, v0
    v_lshl_add_u32 v7, v3, 11, v7
    v_mov_b32 v3, 1
    s_lshl_b32 s43, s4, 3
    s_add_u32 s43, s43, s5
    s_lshl_b32 s43, s43, 9
    s_add_u32 s43, s43, 32768
    v_mov_b32 v108, 0
    v_mov_b32 v109, 0
    v_mov_b32 v110, 0
    v_mov_b32 v111, 0
    v_mov_b32 v112, 0
    v_mov_b32 v113, 0
    v_mov_b32 v114, 0
    v_mov_b32 v115, 0
L_pl_35:
    ds_read_b32 v2, v1 offset:32
    s_waitcnt lgkmcnt(0)
    v_readfirstlane_b32 s44, v2
    s_cmp_ge_u32 s44, 1
    s_cbranch_scc1 L_pd_36
    s_sleep 1
    s_sub_u32 s7, s7, 1
    s_cbranch_scc0 L_pl_35
    s_endpgm
L_pd_36:
    s_add_u32 s6, s6, 1
    s_mov_b32 s48, 0
    v_mov_b32 v9, 112
L_s1_round:
    ds_read2_b32 v[14:15], v4 offset0:0 offset1:4
    ds_read2_b32 v[16:17], v4 offset0:8 offset1:12
    ds_read_b32 v18, v4 offset:64
    s_waitcnt lgkmcnt(0)
    v_perm_b32 v44, v14, v14, v84
    v_perm_b32 v45, v14, v14, v85
    v_perm_b32 v46, v14, v14, v86
    v_perm_b32 v47, v14, v14, v87
    v_perm_b32 v48, v14, v14, v88
    v_perm_b32 v49, v14, v14, v89
    v_perm_b32 v50, v14, v14, v90
    v_perm_b32 v51, v14, v14, v91
    v_perm_b32 v52, v15, v15, v84
    v_perm_b32 v53, v15, v15, v85
    v_perm_b32 v54, v15, v15, v86
    v_perm_b32 v55, v15, v15, v87
    v_perm_b32 v56, v15, v15, v88
    v_perm_b32 v57, v15, v15, v89
    v_perm_b32 v58, v15, v15, v90
    v_perm_b32 v59, v15, v15, v91
    v_perm_b32 v60, v16, v16, v84
    v_perm_b32 v61, v16, v16, v85
    v_perm_b32 v62, v16, v16, v86
    v_perm_b32 v63, v16, v16, v87
    v_perm_b32 v64, v16, v16, v88
    v_perm_b32 v65, v16, v16, v89
    v_perm_b32 v66, v16, v16, v90
    v_perm_b32 v67, v16, v16, v91
    v_perm_b32 v68, v17, v17, v84
    v_perm_b32 v69, v17, v17, v85
    v_perm_b32 v70, v17, v17, v86
    v_perm_b32 v71, v17, v17, v87
    v_perm_b32 v72, v17, v17, v88
    v_perm_b32 v73, v17, v17, v89
    v_perm_b32 v74, v17, v17, v90
    v_perm_b32 v75, v17, v17, v91
    v_perm_b32 v76, v18, v18, v84
    v_perm_b32 v77, v18, v18, v85
    v_perm_b32 v78, v18, v18, v86
    v_perm_b32 v79, v18, v18, v87
    v_perm_b32 v80, v18, v18, v88
    v_perm_b32 v81, v18, v18, v89
    v_perm_b32 v82, v18, v18, v90
    v_perm_b32 v83, v18, v18, v91
L_pl_37:
    ds_read_b32 v2, v9 offset:0
    s_waitcnt lgkmcnt(0)
    v_readfirstlane_b32 s44, v2
    s_cmp_ge_u32 s44, 1
    s_cbranch_scc1 L_pd_38
    s_sleep 1
    s_sub_u32 s7, s7, 1
    s_cbranch_scc0 L_pl_37
    s_endpgm
L_pd_38:
    ds_read_b128 v[24:27], v5 offset:0
    ds_read_b128 v[28:31], v5 offset:1024
    ds_read_b128 v[32:35], v5 offset:2048
    ds_read_b128 v[36:39], v5 offset:3072
    ds_read_b128 v[40:43], v5 offset:4096
    s_mov_b64 exec, 1
    ds_add_u32 v1, v3 offset:48
    s_mov_b64 exec, -1
    v_mov_b32 v9, 0
    v_add_u32 v5, -49152, v5
    s_waitcnt lgkmcnt(1)
    v_mfma_f32_16x16x32_bf16 v[108:111], v[24:27], v[44:47], v[108:111]
    v_mfma_f32_16x16x32_bf16 v[112:115], v[24:27], v[48:51], v[112:115]
    v_mfma_f32_16x16x32_bf16 v[108:111], v[28:31], v[52:55], v[108:111]
    v_mfma_f32_16x16x32_bf16 v[112:115], v[28:31], v[56:59], v[112:115]
    v_mfma_f32_16x16x32_bf16 v[108:111], v[32:35], v[60:63], v[108:111]
    v_mfma_f32_16x16x32_bf16 v[112:115], v[32:35], v[64:67], v[112:115]
    v_mfma_f32_16x16x32_bf16 v[108:111], v[36:39], v[68:71], v[108:111]
    v_mfma_f32_16x16x32_bf16 v[112:115], v[36:39], v[72:75], v[112:115]
    v_mfma_f32_16x16x32_bf16 v[108:111], v[40:43], v[76:79], v[108:111]
    v_mfma_f32_16x16x32_bf16 v[112:115], v[40:43], v[80:83], v[112:115]
    v_add_u32 v4, 640, v4
    s_add_u32 s48, s48, 1
    s_cmp_le_u32 s48, s49
    s_cbranch_scc1 L_s1_round
    s_nop 3
    v_permlane32_swap_b32 v112, v8
    v_permlane32_swap_b32 v113, v9
    v_permlane32_swap_b32 v114, v10
    v_permlane32_swap_b32 v115, v11
    v_add_f32 v108, v108, v8
    v_add_f32 v109, v109, v9
    v_add_f32 v110, v110, v10
    v_add_f32 v111, v111, v11
    s_mov_b32 exec_hi, 0
    ds_write_b128 v6, v[108:111] offset:8192
    s_mov_b64 exec, 1
    ds_add_rtn_u32 v2, v1, v3 offset:24
    s_mov_b64 exec, -1
    s_waitcnt lgkmcnt(0)
    v_readfirstlane_b32 s44, v2
    s_cmp_eq_u32 s44, 7
    s_cbranch_scc0 L_hold
    ds_read_b128 v[8:11], v7 offset:8192
    ds_read_b128 v[12:15], v7 offset:8704
    ds_read_b128 v[16:19], v7 offset:9216
    ds_read_b128 v[20:23], v7 offset:9728
    s_cmp_eq_u32 s49, 0
    s_cselect_b32 s44, 7, 0xff
    v_mov_b32 v2, s44
    v_lshlrev_b32 v4, 4, v0
    s_waitcnt lgkmcnt(0)
    v_pk_add_f32 v[8:9], v[8:9], v[16:17]
    v_pk_add_f32 v[10:11], v[10:11], v[18:19]
    v_pk_add_f32 v[12:13], v[12:13], v[20:21]
    v_pk_add_f32 v[14:15], v[14:15], v[22:23]
    v_pk_add_f32 v[8:9], v[8:9], v[12:13]
    v_pk_add_f32 v[10:11], v[10:11], v[14:15]
    s_nop 1
    v_permlane32_swap_b32 v8, v12
    v_permlane32_swap_b32 v9, v13
    v_permlane32_swap_b32 v10, v14
    v_permlane32_swap_b32 v11, v15
    v_add_f32 v8, v8, v12
    v_add_f32 v9, v9, v13
    v_add_f32 v10, v10, v14
    v_add_f32 v11, v11, v15
    v_bfi_b32 v8, v2, s6, v8
    v_bfi_b32 v9, v2, s6, v9
    v_bfi_b32 v10, v2, s6, v10
    v_bfi_b32 v11, v2, s6, v11
    s_mov_b32 exec_hi, 0
    buffer_store_dwordx4 v[8:11], v4, s[12:15], s43 offen sc1
    ds_write_b32 v1, v3 offset:52
    s_mov_b64 exec, -1
    s_branch L_hold
L_hold_bar:
    s_waitcnt lgkmcnt(0)
    s_add_u32 s6, s6, 1
L_hold:
    s_mov_b32 s8, s24
    s_mov_b32 s9, s25
    s_mov_b32 s10, 7864320
    s_mov_b32 s11, 0x20000
    s_sub_u32 s40, s3, 4
    v_and_b32 v2, 1, v0
    v_lshlrev_b32 v2, 4, v2
    v_mov_b32 v3, 0xffff
    v_lshlrev_b32 v2, v2, v3
    v_bfe_u32 v3, v0, 1, 2
    v_cmp_eq_u32 vcc, 0, v3
    s_nop 1
    v_cndmask_b32 v4, 0, v2, vcc
    v_cmp_eq_u32 vcc, 1, v3
    s_nop 1
    v_cndmask_b32 v5, 0, v2, vcc
    v_cmp_eq_u32 vcc, 2, v3
    s_nop 1
    v_cndmask_b32 v6, 0, v2, vcc
    v_cmp_eq_u32 vcc, 3, v3
    s_nop 1
    v_cndmask_b32 v7, 0, v2, vcc
    v_lshrrev_b32 v8, 4, v0
    v_bfe_u32 v9, v0, 3, 1
    v_sub_u32 v9, v8, v9
    v_mov_b32 v10, 0x3f803f80
    v_cmp_eq_u32 vcc, 0, v9
    s_nop 1
    v_cndmask_b32 v11, 0, v10, vcc
    v_and_b32 v20, v11, v4
    v_and_b32 v21, v11, v5
    v_and_b32 v22, v11, v6
    v_and_b32 v23, v11, v7
    v_cmp_eq_u32 vcc, 2, v9
    s_nop 1
    v_cndmask_b32 v11, 0, v10, vcc
    v_and_b32 v24, v11, v4
    v_and_b32 v25, v11, v5
    v_and_b32 v26, v11, v6
    v_and_b32 v27, v11, v7
    v_and_b32 v3, 3, v0
    v_lshlrev_b32 v3, 2, v3
    v_bfe_u32 v9, v0, 2, 1
    v_add_u32 v3, v3, v9
    v_mul_u32_u24 v3, 2560, v3
    v_lshl_add_u32 v3, v8, 4, v3
    v_and_b32 v9, 8, v0
    v_lshl_add_u32 v3, v9, 3, v3
    s_mul_i32 s41, s4, 245760
    s_lshl_b32 s42, s40, 7
    s_add_u32 s41, s41, s42
    s_mov_b32 s50, 0
    s_mov_b32 s44, s40
L_h_mod:
    s_cmp_lt_u32 s44, 4
    s_cbranch_scc1 L_h_modd
    s_sub_u32 s44, s44, 4
    s_branch L_h_mod
L_h_modd:
    s_add_u32 s44, s44, 12
    s_add_u32 s42, s41, 5120
    s_cmp_ge_u32 s50, s44
    s_cbranch_scc1 L_pd_40
L_pl_39:
    ds_read_b32 v2, v1 offset:0
    s_waitcnt lgkmcnt(0)
    v_readfirstlane_b32 s50, v2
    s_cmp_ge_u32 s50, s44
    s_cbranch_scc1 L_pd_40
    s_sleep 8
    s_sub_u32 s7, s7, 1
    s_cbranch_scc0 L_pl_39
    s_endpgm
L_pd_40:
    buffer_load_dwordx4 v[32:35], v3, s[8:11], s41 offen offset:0 nt
    s_add_u32 s44, s44, 4
    s_cmp_ge_u32 s50, s44
    s_cbranch_scc1 L_pd_42
L_pl_41:
    ds_read_b32 v2, v1 offset:0
    s_waitcnt lgkmcnt(0)
    v_readfirstlane_b32 s50, v2
    s_cmp_ge_u32 s50, s44
    s_cbranch_scc1 L_pd_42
    s_sleep 8
    s_sub_u32 s7, s7, 1
    s_cbranch_scc0 L_pl_41
    s_endpgm
L_pd_42:
    buffer_load_dwordx4 v[56:59], v3, s[8:11], s42 offen offset:0 nt
    s_add_u32 s44, s44, 4
    s_cmp_ge_u32 s50, s44
    s_cbranch_scc1 L_pd_44
L_pl_43:
    ds_read_b32 v2, v1 offset:0
    s_waitcnt lgkmcnt(0)
    v_readfirstlane_b32 s50, v2
    s_cmp_ge_u32 s50, s44
    s_cbranch_scc1 L_pd_44
    s_sleep 8
    s_sub_u32 s7, s7, 1
    s_cbranch_scc0 L_pl_43
    s_endpgm
L_pd_44:
    buffer_load_dwordx4 v[80:83], v3, s[8:11], s41 offen offset:1280 nt
    s_add_u32 s44, s44, 4
    s_cmp_ge_u32 s50, s44
    s_cbranch_scc1 L_pd_46
L_pl_45:
    ds_read_b32 v2, v1 offset:0
    s_waitcnt lgkmcnt(0)
    v_readfirstlane_b32 s50, v2
    s_cmp_ge_u32 s50, s44
    s_cbranch_scc1 L_pd_46
    s_sleep 8
    s_sub_u32 s7, s7, 1
    s_cbranch_scc0 L_pl_45
    s_endpgm
L_pd_46:
    buffer_load_dwordx4 v[104:107], v3, s[8:11], s42 offen offset:1280 nt
    s_add_u32 s44, s44, 4
    s_add_u32 s41, s41, 40960
    s_waitcnt vmcnt(0)
    v_mfma_f32_16x16x32_bf16 v[4:7], v[32:35], v[20:23], 0
    v_mfma_f32_16x16x32_bf16 v[8:11], v[56:59], v[20:23], 0
    v_mfma_f32_16x16x32_bf16 v[12:15], v[32:35], v[24:27], 0
    v_mfma_f32_16x16x32_bf16 v[16:19], v[56:59], v[24:27], 0
    s_nop 7
    v_cvt_pk_bf16_f32 v32, v4, v5
    v_cvt_pk_bf16_f32 v33, v6, v7
    v_cvt_pk_bf16_f32 v28, v8, v9
    v_cvt_pk_bf16_f32 v29, v10, v11
    v_cvt_pk_bf16_f32 v56, v12, v13
    v_cvt_pk_bf16_f32 v57, v14, v15
    v_cvt_pk_bf16_f32 v30, v16, v17
    v_cvt_pk_bf16_f32 v31, v18, v19
    v_mfma_f32_16x16x32_bf16 v[4:7], v[80:83], v[20:23], 0
    v_mfma_f32_16x16x32_bf16 v[8:11], v[104:107], v[20:23], 0
    v_mfma_f32_16x16x32_bf16 v[12:15], v[80:83], v[24:27], 0
    v_mfma_f32_16x16x32_bf16 v[16:19], v[104:107], v[24:27], 0
    s_nop 7
    v_cvt_pk_bf16_f32 v34, v4, v5
    v_cvt_pk_bf16_f32 v35, v6, v7
    v_cvt_pk_bf16_f32 v82, v8, v9
    v_cvt_pk_bf16_f32 v83, v10, v11
    v_cvt_pk_bf16_f32 v58, v12, v13
    v_cvt_pk_bf16_f32 v59, v14, v15
    v_cvt_pk_bf16_f32 v106, v16, v17
    v_cvt_pk_bf16_f32 v107, v18, v19
    v_mov_b32 v80, v28
    v_mov_b32 v104, v30
    v_mov_b32 v81, v29
    v_mov_b32 v105, v31
    s_nop 1
    v_permlane32_swap_b32 v32, v80
    v_permlane32_swap_b32 v33, v81
    v_permlane32_swap_b32 v34, v82
    v_permlane32_swap_b32 v35, v83
    v_permlane32_swap_b32 v56, v104
    v_permlane32_swap_b32 v57, v105
    v_permlane32_swap_b32 v58, v106
    v_permlane32_swap_b32 v59, v107
    s_add_u32 s42, s41, 5120
    s_cmp_ge_u32 s50, s44
    s_cbranch_scc1 L_pd_48
L_pl_47:
    ds_read_b32 v2, v1 offset:0
    s_waitcnt lgkmcnt(0)
    v_readfirstlane_b32 s50, v2
    s_cmp_ge_u32 s50, s44
    s_cbranch_scc1 L_pd_48
    s_sleep 8
    s_sub_u32 s7, s7, 1
    s_cbranch_scc0 L_pl_47
    s_endpgm
L_pd_48:
    buffer_load_dwordx4 v[36:39], v3, s[8:11], s41 offen offset:0 nt
    s_add_u32 s44, s44, 4
    s_cmp_ge_u32 s50, s44
    s_cbranch_scc1 L_pd_50
L_pl_49:
    ds_read_b32 v2, v1 offset:0
    s_waitcnt lgkmcnt(0)
    v_readfirstlane_b32 s50, v2
    s_cmp_ge_u32 s50, s44
    s_cbranch_scc1 L_pd_50
    s_sleep 8
    s_sub_u32 s7, s7, 1
    s_cbranch_scc0 L_pl_49
    s_endpgm
L_pd_50:
    buffer_load_dwordx4 v[60:63], v3, s[8:11], s42 offen offset:0 nt
    s_add_u32 s44, s44, 4
    s_cmp_ge_u32 s50, s44
    s_cbranch_scc1 L_pd_52
L_pl_51:
    ds_read_b32 v2, v1 offset:0
    s_waitcnt lgkmcnt(0)
    v_readfirstlane_b32 s50, v2
    s_cmp_ge_u32 s50, s44
    s_cbranch_scc1 L_pd_52
    s_sleep 8
    s_sub_u32 s7, s7, 1
    s_cbranch_scc0 L_pl_51
    s_endpgm
L_pd_52:
    buffer_load_dwordx4 v[84:87], v3, s[8:11], s41 offen offset:1280 nt
    s_add_u32 s44, s44, 4
    s_cmp_ge_u32 s50, s44
    s_cbranch_scc1 L_pd_54
L_pl_53:
    ds_read_b32 v2, v1 offset:0
    s_waitcnt lgkmcnt(0)
    v_readfirstlane_b32 s50, v2
    s_cmp_ge_u32 s50, s44
    s_cbranch_scc1 L_pd_54
    s_sleep 8
    s_sub_u32 s7, s7, 1
    s_cbranch_scc0 L_pl_53
    s_endpgm
L_pd_54:
    buffer_load_dwordx4 v[108:111], v3, s[8:11], s42 offen offset:1280 nt
    s_add_u32 s44, s44, 4
    s_add_u32 s41, s41, 40960
    s_waitcnt vmcnt(0)
    v_mfma_f32_16x16x32_bf16 v[4:7], v[36:39], v[20:23], 0
    v_mfma_f32_16x16x32_bf16 v[8:11], v[60:63], v[20:23], 0
    v_mfma_f32_16x16x32_bf16 v[12:15], v[36:39], v[24:27], 0
    v_mfma_f32_16x16x32_bf16 v[16:19], v[60:63], v[24:27], 0
    s_nop 7
    v_cvt_pk_bf16_f32 v36, v4, v5
    v_cvt_pk_bf16_f32 v37, v6, v7
    v_cvt_pk_bf16_f32 v28, v8, v9
    v_cvt_pk_bf16_f32 v29, v10, v11
    v_cvt_pk_bf16_f32 v60, v12, v13
    v_cvt_pk_bf16_f32 v61, v14, v15
    v_cvt_pk_bf16_f32 v30, v16, v17
    v_cvt_pk_bf16_f32 v31, v18, v19
    v_mfma_f32_16x16x32_bf16 v[4:7], v[84:87], v[20:23], 0
    v_mfma_f32_16x16x32_bf16 v[8:11], v[108:111], v[20:23], 0
    v_mfma_f32_16x16x32_bf16 v[12:15], v[84:87], v[24:27], 0
    v_mfma_f32_16x16x32_bf16 v[16:19], v[108:111], v[24:27], 0
    s_nop 7
    v_cvt_pk_bf16_f32 v38, v4, v5
    v_cvt_pk_bf16_f32 v39, v6, v7
    v_cvt_pk_bf16_f32 v86, v8, v9
    v_cvt_pk_bf16_f32 v87, v10, v11
    v_cvt_pk_bf16_f32 v62, v12, v13
    v_cvt_pk_bf16_f32 v63, v14, v15
    v_cvt_pk_bf16_f32 v110, v16, v17
    v_cvt_pk_bf16_f32 v111, v18, v19
    v_mov_b32 v84, v28
    v_mov_b32 v108, v30
    v_mov_b32 v85, v29
    v_mov_b32 v109, v31
    s_nop 1
    v_permlane32_swap_b32 v36, v84
    v_permlane32_swap_b32 v37, v85
    v_permlane32_swap_b32 v38, v86
    v_permlane32_swap_b32 v39, v87
    v_permlane32_swap_b32 v60, v108
    v_permlane32_swap_b32 v61, v109
    v_permlane32_swap_b32 v62, v110
    v_permlane32_swap_b32 v63, v111
    s_add_u32 s42, s41, 5120
    s_cmp_ge_u32 s50, s44
    s_cbranch_scc1 L_pd_56
L_pl_55:
    ds_read_b32 v2, v1 offset:0
    s_waitcnt lgkmcnt(0)
    v_readfirstlane_b32 s50, v2
    s_cmp_ge_u32 s50, s44
    s_cbranch_scc1 L_pd_56
    s_sleep 8
    s_sub_u32 s7, s7, 1
    s_cbranch_scc0 L_pl_55
    s_endpgm
L_pd_56:
    buffer_load_dwordx4 v[40:43], v3, s[8:11], s41 offen offset:0 nt
    s_add_u32 s44, s44, 4
    s_cmp_ge_u32 s50, s44
    s_cbranch_scc1 L_pd_58
L_pl_57:
    ds_read_b32 v2, v1 offset:0
    s_waitcnt lgkmcnt(0)
    v_readfirstlane_b32 s50, v2
    s_cmp_ge_u32 s50, s44
    s_cbranch_scc1 L_pd_58
    s_sleep 8
    s_sub_u32 s7, s7, 1
    s_cbranch_scc0 L_pl_57
    s_endpgm
L_pd_58:
    buffer_load_dwordx4 v[64:67], v3, s[8:11], s42 offen offset:0 nt
    s_add_u32 s44, s44, 4
    s_cmp_ge_u32 s50, s44
    s_cbranch_scc1 L_pd_60
L_pl_59:
    ds_read_b32 v2, v1 offset:0
    s_waitcnt lgkmcnt(0)
    v_readfirstlane_b32 s50, v2
    s_cmp_ge_u32 s50, s44
    s_cbranch_scc1 L_pd_60
    s_sleep 8
    s_sub_u32 s7, s7, 1
    s_cbranch_scc0 L_pl_59
    s_endpgm
L_pd_60:
    buffer_load_dwordx4 v[88:91], v3, s[8:11], s41 offen offset:1280 nt
    s_add_u32 s44, s44, 4
    s_cmp_ge_u32 s50, s44
    s_cbranch_scc1 L_pd_62
L_pl_61:
    ds_read_b32 v2, v1 offset:0
    s_waitcnt lgkmcnt(0)
    v_readfirstlane_b32 s50, v2
    s_cmp_ge_u32 s50, s44
    s_cbranch_scc1 L_pd_62
    s_sleep 8
    s_sub_u32 s7, s7, 1
    s_cbranch_scc0 L_pl_61
    s_endpgm
L_pd_62:
    buffer_load_dwordx4 v[112:115], v3, s[8:11], s42 offen offset:1280 nt
    s_add_u32 s44, s44, 4
    s_add_u32 s41, s41, 40960
    s_waitcnt vmcnt(0)
    v_mfma_f32_16x16x32_bf16 v[4:7], v[40:43], v[20:23], 0
    v_mfma_f32_16x16x32_bf16 v[8:11], v[64:67], v[20:23], 0
    v_mfma_f32_16x16x32_bf16 v[12:15], v[40:43], v[24:27], 0
    v_mfma_f32_16x16x32_bf16 v[16:19], v[64:67], v[24:27], 0
    s_nop 7
    v_cvt_pk_bf16_f32 v40, v4, v5
    v_cvt_pk_bf16_f32 v41, v6, v7
    v_cvt_pk_bf16_f32 v28, v8, v9
    v_cvt_pk_bf16_f32 v29, v10, v11
    v_cvt_pk_bf16_f32 v64, v12, v13
    v_cvt_pk_bf16_f32 v65, v14, v15
    v_cvt_pk_bf16_f32 v30, v16, v17
    v_cvt_pk_bf16_f32 v31, v18, v19
    v_mfma_f32_16x16x32_bf16 v[4:7], v[88:91], v[20:23], 0
    v_mfma_f32_16x16x32_bf16 v[8:11], v[112:115], v[20:23], 0
    v_mfma_f32_16x16x32_bf16 v[12:15], v[88:91], v[24:27], 0
    v_mfma_f32_16x16x32_bf16 v[16:19], v[112:115], v[24:27], 0
    s_nop 7
    v_cvt_pk_bf16_f32 v42, v4, v5
    v_cvt_pk_bf16_f32 v43, v6, v7
    v_cvt_pk_bf16_f32 v90, v8, v9
    v_cvt_pk_bf16_f32 v91, v10, v11
    v_cvt_pk_bf16_f32 v66, v12, v13
    v_cvt_pk_bf16_f32 v67, v14, v15
    v_cvt_pk_bf16_f32 v114, v16, v17
    v_cvt_pk_bf16_f32 v115, v18, v19
    v_mov_b32 v88, v28
    v_mov_b32 v112, v30
    v_mov_b32 v89, v29
    v_mov_b32 v113, v31
    s_nop 1
    v_permlane32_swap_b32 v40, v88
    v_permlane32_swap_b32 v41, v89
    v_permlane32_swap_b32 v42, v90
    v_permlane32_swap_b32 v43, v91
    v_permlane32_swap_b32 v64, v112
    v_permlane32_swap_b32 v65, v113
    v_permlane32_swap_b32 v66, v114
    v_permlane32_swap_b32 v67, v115
    s_add_u32 s42, s41, 5120
    s_cmp_ge_u32 s50, s44
    s_cbranch_scc1 L_pd_64
L_pl_63:
    ds_read_b32 v2, v1 offset:0
    s_waitcnt lgkmcnt(0)
    v_readfirstlane_b32 s50, v2
    s_cmp_ge_u32 s50, s44
    s_cbranch_scc1 L_pd_64
    s_sleep 8
    s_sub_u32 s7, s7, 1
    s_cbranch_scc0 L_pl_63
    s_endpgm
L_pd_64:
    buffer_load_dwordx4 v[44:47], v3, s[8:11], s41 offen offset:0 nt
    s_add_u32 s44, s44, 4
    s_cmp_ge_u32 s50, s44
    s_cbranch_scc1 L_pd_66
L_pl_65:
    ds_read_b32 v2, v1 offset:0
    s_waitcnt lgkmcnt(0)
    v_readfirstlane_b32 s50, v2
    s_cmp_ge_u32 s50, s44
    s_cbranch_scc1 L_pd_66
    s_sleep 8
    s_sub_u32 s7, s7, 1
    s_cbranch_scc0 L_pl_65
    s_endpgm
L_pd_66:
    buffer_load_dwordx4 v[68:71], v3, s[8:11], s42 offen offset:0 nt
    s_add_u32 s44, s44, 4
    s_cmp_ge_u32 s50, s44
    s_cbranch_scc1 L_pd_68
L_pl_67:
    ds_read_b32 v2, v1 offset:0
    s_waitcnt lgkmcnt(0)
    v_readfirstlane_b32 s50, v2
    s_cmp_ge_u32 s50, s44
    s_cbranch_scc1 L_pd_68
    s_sleep 8
    s_sub_u32 s7, s7, 1
    s_cbranch_scc0 L_pl_67
    s_endpgm
L_pd_68:
    buffer_load_dwordx4 v[92:95], v3, s[8:11], s41 offen offset:1280 nt
    s_add_u32 s44, s44, 4
    s_cmp_ge_u32 s50, s44
    s_cbranch_scc1 L_pd_70
L_pl_69:
    ds_read_b32 v2, v1 offset:0
    s_waitcnt lgkmcnt(0)
    v_readfirstlane_b32 s50, v2
    s_cmp_ge_u32 s50, s44
    s_cbranch_scc1 L_pd_70
    s_sleep 8
    s_sub_u32 s7, s7, 1
    s_cbranch_scc0 L_pl_69
    s_endpgm
L_pd_70:
    buffer_load_dwordx4 v[116:119], v3, s[8:11], s42 offen offset:1280 nt
    s_add_u32 s44, s44, 4
    s_add_u32 s41, s41, 40960
    s_waitcnt vmcnt(0)
    v_mfma_f32_16x16x32_bf16 v[4:7], v[44:47], v[20:23], 0
    v_mfma_f32_16x16x32_bf16 v[8:11], v[68:71], v[20:23], 0
    v_mfma_f32_16x16x32_bf16 v[12:15], v[44:47], v[24:27], 0
    v_mfma_f32_16x16x32_bf16 v[16:19], v[68:71], v[24:27], 0
    s_nop 7
    v_cvt_pk_bf16_f32 v44, v4, v5
    v_cvt_pk_bf16_f32 v45, v6, v7
    v_cvt_pk_bf16_f32 v28, v8, v9
    v_cvt_pk_bf16_f32 v29, v10, v11
    v_cvt_pk_bf16_f32 v68, v12, v13
    v_cvt_pk_bf16_f32 v69, v14, v15
    v_cvt_pk_bf16_f32 v30, v16, v17
    v_cvt_pk_bf16_f32 v31, v18, v19
    v_mfma_f32_16x16x32_bf16 v[4:7], v[92:95], v[20:23], 0
    v_mfma_f32_16x16x32_bf16 v[8:11], v[116:119], v[20:23], 0
    v_mfma_f32_16x16x32_bf16 v[12:15], v[92:95], v[24:27], 0
    v_mfma_f32_16x16x32_bf16 v[16:19], v[116:119], v[24:27], 0
    s_nop 7
    v_cvt_pk_bf16_f32 v46, v4, v5
    v_cvt_pk_bf16_f32 v47, v6, v7
    v_cvt_pk_bf16_f32 v94, v8, v9
    v_cvt_pk_bf16_f32 v95, v10, v11
    v_cvt_pk_bf16_f32 v70, v12, v13
    v_cvt_pk_bf16_f32 v71, v14, v15
    v_cvt_pk_bf16_f32 v118, v16, v17
    v_cvt_pk_bf16_f32 v119, v18, v19
    v_mov_b32 v92, v28
    v_mov_b32 v116, v30
    v_mov_b32 v93, v29
    v_mov_b32 v117, v31
    s_nop 1
    v_permlane32_swap_b32 v44, v92
    v_permlane32_swap_b32 v45, v93
    v_permlane32_swap_b32 v46, v94
    v_permlane32_swap_b32 v47, v95
    v_permlane32_swap_b32 v68, v116
    v_permlane32_swap_b32 v69, v117
    v_permlane32_swap_b32 v70, v118
    v_permlane32_swap_b32 v71, v119
    s_add_u32 s42, s41, 5120
    s_cmp_ge_u32 s50, s44
    s_cbranch_scc1 L_pd_72
L_pl_71:
    ds_read_b32 v2, v1 offset:0
    s_waitcnt lgkmcnt(0)
    v_readfirstlane_b32 s50, v2
    s_cmp_ge_u32 s50, s44
    s_cbranch_scc1 L_pd_72
    s_sleep 8
    s_sub_u32 s7, s7, 1
    s_cbranch_scc0 L_pl_71
    s_endpgm
L_pd_72:
    buffer_load_dwordx4 v[48:51], v3, s[8:11], s41 offen offset:0 nt
    s_add_u32 s44, s44, 4
    s_cmp_ge_u32 s50, s44
    s_cbranch_scc1 L_pd_74
L_pl_73:
    ds_read_b32 v2, v1 offset:0
    s_waitcnt lgkmcnt(0)
    v_readfirstlane_b32 s50, v2
    s_cmp_ge_u32 s50, s44
    s_cbranch_scc1 L_pd_74
    s_sleep 8
    s_sub_u32 s7, s7, 1
    s_cbranch_scc0 L_pl_73
    s_endpgm
L_pd_74:
    buffer_load_dwordx4 v[72:75], v3, s[8:11], s42 offen offset:0 nt
    s_add_u32 s44, s44, 4
    s_cmp_ge_u32 s50, s44
    s_cbranch_scc1 L_pd_76
L_pl_75:
    ds_read_b32 v2, v1 offset:0
    s_waitcnt lgkmcnt(0)
    v_readfirstlane_b32 s50, v2
    s_cmp_ge_u32 s50, s44
    s_cbranch_scc1 L_pd_76
    s_sleep 8
    s_sub_u32 s7, s7, 1
    s_cbranch_scc0 L_pl_75
    s_endpgm
L_pd_76:
    buffer_load_dwordx4 v[96:99], v3, s[8:11], s41 offen offset:1280 nt
    s_add_u32 s44, s44, 4
    s_cmp_ge_u32 s50, s44
    s_cbranch_scc1 L_pd_78
L_pl_77:
    ds_read_b32 v2, v1 offset:0
    s_waitcnt lgkmcnt(0)
    v_readfirstlane_b32 s50, v2
    s_cmp_ge_u32 s50, s44
    s_cbranch_scc1 L_pd_78
    s_sleep 8
    s_sub_u32 s7, s7, 1
    s_cbranch_scc0 L_pl_77
    s_endpgm
L_pd_78:
    buffer_load_dwordx4 v[120:123], v3, s[8:11], s42 offen offset:1280 nt
    s_add_u32 s44, s44, 4
    s_add_u32 s41, s41, 40960
    s_waitcnt vmcnt(0)
    v_mfma_f32_16x16x32_bf16 v[4:7], v[48:51], v[20:23], 0
    v_mfma_f32_16x16x32_bf16 v[8:11], v[72:75], v[20:23], 0
    v_mfma_f32_16x16x32_bf16 v[12:15], v[48:51], v[24:27], 0
    v_mfma_f32_16x16x32_bf16 v[16:19], v[72:75], v[24:27], 0
    s_nop 7
    v_cvt_pk_bf16_f32 v48, v4, v5
    v_cvt_pk_bf16_f32 v49, v6, v7
    v_cvt_pk_bf16_f32 v28, v8, v9
    v_cvt_pk_bf16_f32 v29, v10, v11
    v_cvt_pk_bf16_f32 v72, v12, v13
    v_cvt_pk_bf16_f32 v73, v14, v15
    v_cvt_pk_bf16_f32 v30, v16, v17
    v_cvt_pk_bf16_f32 v31, v18, v19
    v_mfma_f32_16x16x32_bf16 v[4:7], v[96:99], v[20:23], 0
    v_mfma_f32_16x16x32_bf16 v[8:11], v[120:123], v[20:23], 0
    v_mfma_f32_16x16x32_bf16 v[12:15], v[96:99], v[24:27], 0
    v_mfma_f32_16x16x32_bf16 v[16:19], v[120:123], v[24:27], 0
    s_nop 7
    v_cvt_pk_bf16_f32 v50, v4, v5
    v_cvt_pk_bf16_f32 v51, v6, v7
    v_cvt_pk_bf16_f32 v98, v8, v9
    v_cvt_pk_bf16_f32 v99, v10, v11
    v_cvt_pk_bf16_f32 v74, v12, v13
    v_cvt_pk_bf16_f32 v75, v14, v15
    v_cvt_pk_bf16_f32 v122, v16, v17
    v_cvt_pk_bf16_f32 v123, v18, v19
    v_mov_b32 v96, v28
    v_mov_b32 v120, v30
    v_mov_b32 v97, v29
    v_mov_b32 v121, v31
    s_nop 1
    v_permlane32_swap_b32 v48, v96
    v_permlane32_swap_b32 v49, v97
    v_permlane32_swap_b32 v50, v98
    v_permlane32_swap_b32 v51, v99
    v_permlane32_swap_b32 v72, v120
    v_permlane32_swap_b32 v73, v121
    v_permlane32_swap_b32 v74, v122
    v_permlane32_swap_b32 v75, v123
    s_add_u32 s42, s41, 5120
    s_cmp_ge_u32 s50, s44
    s_cbranch_scc1 L_pd_80
L_pl_79:
    ds_read_b32 v2, v1 offset:0
    s_waitcnt lgkmcnt(0)
    v_readfirstlane_b32 s50, v2
    s_cmp_ge_u32 s50, s44
    s_cbranch_scc1 L_pd_80
    s_sleep 8
    s_sub_u32 s7, s7, 1
    s_cbranch_scc0 L_pl_79
    s_endpgm
L_pd_80:
    buffer_load_dwordx4 v[52:55], v3, s[8:11], s41 offen offset:0 nt
    s_add_u32 s44, s44, 4
    s_cmp_ge_u32 s50, s44
    s_cbranch_scc1 L_pd_82
L_pl_81:
    ds_read_b32 v2, v1 offset:0
    s_waitcnt lgkmcnt(0)
    v_readfirstlane_b32 s50, v2
    s_cmp_ge_u32 s50, s44
    s_cbranch_scc1 L_pd_82
    s_sleep 8
    s_sub_u32 s7, s7, 1
    s_cbranch_scc0 L_pl_81
    s_endpgm
L_pd_82:
    buffer_load_dwordx4 v[76:79], v3, s[8:11], s42 offen offset:0 nt
    s_add_u32 s44, s44, 4
    s_cmp_ge_u32 s50, s44
    s_cbranch_scc1 L_pd_84
L_pl_83:
    ds_read_b32 v2, v1 offset:0
    s_waitcnt lgkmcnt(0)
    v_readfirstlane_b32 s50, v2
    s_cmp_ge_u32 s50, s44
    s_cbranch_scc1 L_pd_84
    s_sleep 8
    s_sub_u32 s7, s7, 1
    s_cbranch_scc0 L_pl_83
    s_endpgm
L_pd_84:
    buffer_load_dwordx4 v[100:103], v3, s[8:11], s41 offen offset:1280 nt
    s_add_u32 s44, s44, 4
    s_cmp_ge_u32 s50, s44
    s_cbranch_scc1 L_pd_86
L_pl_85:
    ds_read_b32 v2, v1 offset:0
    s_waitcnt lgkmcnt(0)
    v_readfirstlane_b32 s50, v2
    s_cmp_ge_u32 s50, s44
    s_cbranch_scc1 L_pd_86
    s_sleep 8
    s_sub_u32 s7, s7, 1
    s_cbranch_scc0 L_pl_85
    s_endpgm
L_pd_86:
    buffer_load_dwordx4 v[124:127], v3, s[8:11], s42 offen offset:1280 nt
    s_add_u32 s44, s44, 4
    s_add_u32 s41, s41, 40960
    s_waitcnt vmcnt(0)
    v_mfma_f32_16x16x32_bf16 v[4:7], v[52:55], v[20:23], 0
    v_mfma_f32_16x16x32_bf16 v[8:11], v[76:79], v[20:23], 0
    v_mfma_f32_16x16x32_bf16 v[12:15], v[52:55], v[24:27], 0
    v_mfma_f32_16x16x32_bf16 v[16:19], v[76:79], v[24:27], 0
    s_nop 7
    v_cvt_pk_bf16_f32 v52, v4, v5
    v_cvt_pk_bf16_f32 v53, v6, v7
    v_cvt_pk_bf16_f32 v28, v8, v9
    v_cvt_pk_bf16_f32 v29, v10, v11
    v_cvt_pk_bf16_f32 v76, v12, v13
    v_cvt_pk_bf16_f32 v77, v14, v15
    v_cvt_pk_bf16_f32 v30, v16, v17
    v_cvt_pk_bf16_f32 v31, v18, v19
    v_mfma_f32_16x16x32_bf16 v[4:7], v[100:103], v[20:23], 0
    v_mfma_f32_16x16x32_bf16 v[8:11], v[124:127], v[20:23], 0
    v_mfma_f32_16x16x32_bf16 v[12:15], v[100:103], v[24:27], 0
    v_mfma_f32_16x16x32_bf16 v[16:19], v[124:127], v[24:27], 0
    s_nop 7
    v_cvt_pk_bf16_f32 v54, v4, v5
    v_cvt_pk_bf16_f32 v55, v6, v7
    v_cvt_pk_bf16_f32 v102, v8, v9
    v_cvt_pk_bf16_f32 v103, v10, v11
    v_cvt_pk_bf16_f32 v78, v12, v13
    v_cvt_pk_bf16_f32 v79, v14, v15
    v_cvt_pk_bf16_f32 v126, v16, v17
    v_cvt_pk_bf16_f32 v127, v18, v19
    v_mov_b32 v100, v28
    v_mov_b32 v124, v30
    v_mov_b32 v101, v29
    v_mov_b32 v125, v31
    s_nop 1
    v_permlane32_swap_b32 v52, v100
    v_permlane32_swap_b32 v53, v101
    v_permlane32_swap_b32 v54, v102
    v_permlane32_swap_b32 v55, v103
    v_permlane32_swap_b32 v76, v124
    v_permlane32_swap_b32 v77, v125
    v_permlane32_swap_b32 v78, v126
    v_permlane32_swap_b32 v79, v127
    s_cmp_lt_u32 s2, 40
    s_cselect_b32 s57, 8, 0
    s_mov_b32 s58, 0
    s_mov_b32 s59, 0
    s_cmp_lt_u32 s40, s57
    s_cbranch_scc0 L_g_back
L_pl_87:
    ds_read_b32 v2, v1 offset:60
    s_waitcnt lgkmcnt(0)
    v_readfirstlane_b32 s46, v2
    s_cmp_ge_u32 s46, 1
    s_cbranch_scc1 L_pd_88
    s_sleep 16
    s_sub_u32 s7, s7, 1
    s_cbranch_scc0 L_pl_87
    s_endpgm
L_pd_88:
    s_branch L_g_entry
L_g_back:
L_pl_89:
    ds_read_b32 v2, v1 offset:44
    s_waitcnt lgkmcnt(0)
    v_readfirstlane_b32 s46, v2
    s_cmp_ge_u32 s46, 1
    s_cbranch_scc1 L_pd_90
    s_sleep 16
    s_sub_u32 s7, s7, 1
    s_cbranch_scc0 L_pl_89
    s_endpgm
L_pd_90:
    ds_read_b128 v[4:7], v1 offset:96
    v_and_b32 v3, 3, v0
    v_bfe_u32 v2, v0, 2, 1
    v_lshl_add_u32 v3, v3, 1, v2
    v_mul_u32_u24 v3, 192, v3
    v_lshrrev_b32 v2, 4, v0
    v_lshl_add_u32 v3, v2, 4, v3
    v_and_b32 v0, 15, v0
    s_lshl_b32 s42, s40, 8
    v_lshl_add_u32 v0, v0, 4, s42
    s_mov_b32 s41, 0
    s_lshl_b32 s43, s4, 3
    s_add_u32 s43, s43, s5
    s_mul_i32 s43, s43, 2560
    s_add_u32 s43, s43, 688128
    s_add_u32 s46, s43, 652800
    s_mov_b32 s56, s46
    s_mov_b32 s45, 2
    s_waitcnt lgkmcnt(0)
    v_readfirstlane_b32 s52, v4
    v_readfirstlane_b32 s53, v5
    v_readfirstlane_b32 s54, v6
    v_readfirstlane_b32 s55, v7
L_h_seg:
    v_mov_b32 v4, 0
    v_mov_b32 v5, 0
    v_mov_b32 v6, 0
    v_mov_b32 v7, 0
    v_mov_b32 v8, 0
    v_mov_b32 v9, 0
    v_mov_b32 v10, 0
    v_mov_b32 v11, 0
    v_mov_b32 v12, 0
    v_mov_b32 v13, 0
    v_mov_b32 v14, 0
    v_mov_b32 v15, 0
    v_mov_b32 v16, 0
    v_mov_b32 v17, 0
    v_mov_b32 v18, 0
    v_mov_b32 v19, 0
L_pl_91:
    ds_read_b32 v2, v1 offset:16
    s_waitcnt lgkmcnt(0)
    v_readfirstlane_b32 s46, v2
    s_cmp_ge_u32 s46, s45
    s_cbranch_scc1 L_pd_92
    s_sleep 0
    s_sub_u32 s7, s7, 1
    s_cbranch_scc0 L_pl_91
    s_endpgm
L_pd_92:
    ds_read_b128 v[20:23], v3 offset:1024
    ds_read_b128 v[24:27], v3 offset:1088
    ds_read_b128 v[28:31], v3 offset:1152
    v_mov_b32 v2, 0x4444
    s_mov_b32 exec_lo, 0xf0f0f0f0
    s_mov_b32 exec_hi, 0xf0f0f0f0
    v_mov_b32 v2, 0xeeee
    s_mov_b64 exec, -1
    s_waitcnt lgkmcnt(2)
    v_smfmac_f32_16x16x64_bf16 v[4:7], v[20:23], v[32:39], v2
    v_smfmac_f32_16x16x64_bf16 v[8:11], v[20:23], v[56:63], v2
    v_smfmac_f32_16x16x64_bf16 v[12:15], v[20:23], v[80:87], v2
    v_smfmac_f32_16x16x64_bf16 v[16:19], v[20:23], v[104:111], v2
    ds_read_b128 v[20:23], v0 offset:8192
    s_waitcnt lgkmcnt(2)
    v_smfmac_f32_16x16x64_bf16 v[4:7], v[24:27], v[40:47], v2
    v_smfmac_f32_16x16x64_bf16 v[8:11], v[24:27], v[64:71], v2
    v_smfmac_f32_16x16x64_bf16 v[12:15], v[24:27], v[88:95], v2
    v_smfmac_f32_16x16x64_bf16 v[16:19], v[24:27], v[112:119], v2
    s_waitcnt lgkmcnt(1)
    v_smfmac_f32_16x16x64_bf16 v[4:7], v[28:31], v[48:55], v2
    v_smfmac_f32_16x16x64_bf16 v[8:11], v[28:31], v[72:79], v2
    v_smfmac_f32_16x16x64_bf16 v[12:15], v[28:31], v[96:103], v2
    v_smfmac_f32_16x16x64_bf16 v[16:19], v[28:31], v[120:127], v2
    v_mov_b32 v24, 0xff
    s_waitcnt lgkmcnt(0)
    s_nop 2
    v_add_f32 v4, v4, v5
    v_add_f32 v6, v6, v7
    v_add_f32 v8, v8, v9
    v_add_f32 v10, v10, v11
    v_add_f32 v12, v12, v13
    v_add_f32 v14, v14, v15
    v_add_f32 v16, v16, v17
    v_add_f32 v18, v18, v19
    v_fmac_f32 v20, s52, v4
    v_fmac_f32 v21, s52, v8
    v_fmac_f32 v22, s52, v12
    v_fmac_f32 v23, s52, v16
    v_fmac_f32 v20, s53, v6
    v_fmac_f32 v21, s53, v10
    v_fmac_f32 v22, s53, v14
    v_fmac_f32 v23, s53, v18
    v_permlane16_swap_b32 v20, v21
    s_nop 0
    v_permlane16_swap_b32 v22, v23
    v_add_f32 v20, v20, v21
    v_add_f32 v22, v22, v23
    v_bfi_b32 v20, v24, s6, v20
    v_bfi_b32 v22, v24, s6, v22
    s_nop 0
    v_permlane16_swap_b32 v20, v21
    v_permlane16_swap_b32 v22, v23
    s_cmp_eq_u32 s41, 0
    s_cbranch_scc0 L_h_pub
    s_cmp_ge_u32 s50, 124
    s_cbranch_scc1 L_pd_94
L_pl_93:
    ds_read_b32 v2, v1 offset:0
    s_waitcnt lgkmcnt(0)
    v_readfirstlane_b32 s50, v2
    s_cmp_ge_u32 s50, 124
    s_cbranch_scc1 L_pd_94
    s_sleep 8
    s_sub_u32 s7, s7, 1
    s_cbranch_scc0 L_pl_93
    s_endpgm
L_pd_94:
L_pl_95:
    ds_read_b32 v2, v1 offset:16
    s_waitcnt lgkmcnt(0)
    v_readfirstlane_b32 s46, v2
    s_cmp_ge_u32 s46, 3
    s_cbranch_scc1 L_pd_96
    s_sleep 1
    s_sub_u32 s7, s7, 1
    s_cbranch_scc0 L_pl_95
    s_endpgm
L_pd_96:
L_h_pub:
    s_mov_b64 exec, 0xffff
    buffer_store_dwordx4 v[20:23], v0, s[12:15], s43 offen sc1
L_h_nost:
    s_mov_b64 exec, -1
    v_add_u32 v3, 1536, v3
    v_add_u32 v0, 2560, v0
    s_mov_b32 s43, s56
    s_mov_b32 s52, s54
    s_mov_b32 s53, s55
    s_add_u32 s45, s45, 2
    s_add_u32 s41, s41, 1
    s_cmp_lt_u32 s41, 2
    s_cbranch_scc1 L_h_seg
    s_cmp_lt_u32 s40, s57
    s_cbranch_scc0 L_end
    s_mov_b64 s[58:59], -1
L_g_entry:
    v_mbcnt_lo_u32_b32 v24, -1, 0
    v_mbcnt_hi_u32_b32 v24, -1, v24
    s_cmp_ge_u32 s2, 20
    s_cselect_b32 s44, 1, 0
    s_cselect_b32 s45, 20, 0
    s_sub_u32 s45, s2, s45
    s_lshr_b32 s46, s45, 1
    s_lshl_b32 s46, s46, 7
    s_and_b32 s47, s45, 1
    s_lshl_b32 s47, s47, 4
    s_add_u32 s46, s46, s47
    s_mul_i32 s47, s44, 1280
    s_add_u32 s46, s46, s47
    v_bfe_u32 v23, v24, 3, 1
    v_lshlrev_b32 v23, 6, v23
    v_bfe_u32 v22, v24, 4, 1
    v_lshl_add_u32 v23, v22, 5, v23
    v_and_b32 v22, 7, v24
    v_lshl_add_u32 v23, v22, 1, v23
    v_add_u32 v23, s46, v23
    v_lshrrev_b32 v21, 3, v24
    v_mul_u32_u24 v21, 2560, v21
    v_lshl_add_u32 v21, v22, 4, v21
    s_mul_i32 s46, s44, 655360
    s_lshl_b32 s47, s45, 7
    s_add_u32 s46, s46, s47
    s_mul_i32 s47, s40, 81920
    s_add_u32 s46, s46, s47
    s_add_u32 s60, s46, 688128
    s_add_u32 s61, s60, 20480
    s_add_u32 s62, s60, 40960
    s_add_u32 s63, s60, 61440
    s_mov_b64 s[64:65], s[58:59]
    s_mov_b64 s[66:67], s[58:59]
    s_mov_b64 s[68:69], s[58:59]
    s_mov_b64 s[70:71], s[58:59]
    s_mov_b32 s8, s34
    s_mov_b32 s9, s35
    s_mov_b32 s10, 2560
    s_mov_b32 s11, 0x20000
    v_lshrrev_b32 v25, 4, v24
    v_lshl_add_u32 v22, v25, 3, v22
    s_lshl_b32 s47, s40, 7
    v_lshl_add_u32 v22, v22, 2, s47
    v_and_b32 v25, 31, v24
    v_lshlrev_b32 v25, 2, v25
    v_add_u32 v25, 13312, v25
    v_mov_b32 v26, 1
    s_and_b64 s[76:77], s[58:59], 1
    s_cmp_eq_u32 s58, 0
    s_cbranch_scc1 L_gi_97
    s_cmp_eq_u64 s[64:65], 0
    s_cselect_b64 exec, s[76:77], s[64:65]
    buffer_load_dwordx4 v[32:35], v21, s[12:15], s60 offen sc1
    s_cmp_eq_u64 s[66:67], 0
    s_cselect_b64 exec, s[76:77], s[66:67]
    buffer_load_dwordx4 v[36:39], v21, s[12:15], s61 offen sc1
    s_cmp_eq_u64 s[68:69], 0
    s_cselect_b64 exec, s[76:77], s[68:69]
    buffer_load_dwordx4 v[40:43], v21, s[12:15], s62 offen sc1
    s_cmp_eq_u64 s[70:71], 0
    s_cselect_b64 exec, s[76:77], s[70:71]
    buffer_load_dwordx4 v[44:47], v21, s[12:15], s63 offen sc1
L_gi_97:
    s_mov_b32 s78, 0
    s_waitcnt vmcnt(0)
    s_branch L_g_chk0
L_g_poll:
    s_waitcnt vmcnt(0)
L_g_chk0:
    s_mov_b64 exec, s[64:65]
    s_cbranch_execz L_g_v00
    v_xor_b32 v27, s6, v32
    v_bitop3_b32 v27, v27, v33, s6 bitop3:0xf6
    v_bitop3_b32 v27, v27, v34, s6 bitop3:0xf6
    v_bitop3_b32 v27, v27, v35, s6 bitop3:0xf6
    v_and_b32 v4, 0xffffff00, v32
    v_and_b32 v5, 0xffffff00, v33
    v_or_b32_dpp v27, v27, v27 quad_perm:[1,0,3,2] row_mask:0xf bank_mask:0xf
    v_and_b32 v6, 0xffffff00, v34
    v_and_b32 v27, 0xff, v27
    v_cmp_ne_u32 s[64:65], 0, v27
    v_and_b32 v7, 0xffffff00, v35
L_g_v00:
    s_mov_b64 exec, s[66:67]
    s_cbranch_execz L_g_v01
    v_xor_b32 v27, s6, v36
    v_bitop3_b32 v27, v27, v37, s6 bitop3:0xf6
    v_bitop3_b32 v27, v27, v38, s6 bitop3:0xf6
    v_bitop3_b32 v27, v27, v39, s6 bitop3:0xf6
    v_and_b32 v8, 0xffffff00, v36
    v_and_b32 v9, 0xffffff00, v37
    v_or_b32_dpp v27, v27, v27 quad_perm:[1,0,3,2] row_mask:0xf bank_mask:0xf
    v_and_b32 v10, 0xffffff00, v38
    v_and_b32 v27, 0xff, v27
    v_cmp_ne_u32 s[66:67], 0, v27
    v_and_b32 v11, 0xffffff00, v39
L_g_v01:
    s_mov_b64 exec, s[68:69]
    s_cbranch_execz L_g_v02
    v_xor_b32 v27, s6, v40
    v_bitop3_b32 v27, v27, v41, s6 bitop3:0xf6
    v_bitop3_b32 v27, v27, v42, s6 bitop3:0xf6
    v_bitop3_b32 v27, v27, v43, s6 bitop3:0xf6
    v_and_b32 v12, 0xffffff00, v40
    v_and_b32 v13, 0xffffff00, v41
    v_or_b32_dpp v27, v27, v27 quad_perm:[1,0,3,2] row_mask:0xf bank_mask:0xf
    v_and_b32 v14, 0xffffff00, v42
    v_and_b32 v27, 0xff, v27
    v_cmp_ne_u32 s[68:69], 0, v27
    v_and_b32 v15, 0xffffff00, v43
L_g_v02:
    s_mov_b64 exec, s[70:71]
    s_cbranch_execz L_g_v03
    v_xor_b32 v27, s6, v44
    v_bitop3_b32 v27, v27, v45, s6 bitop3:0xf6
    v_bitop3_b32 v27, v27, v46, s6 bitop3:0xf6
    v_bitop3_b32 v27, v27, v47, s6 bitop3:0xf6
    v_and_b32 v16, 0xffffff00, v44
    v_and_b32 v17, 0xffffff00, v45
    v_or_b32_dpp v27, v27, v27 quad_perm:[1,0,3,2] row_mask:0xf bank_mask:0xf
    v_and_b32 v18, 0xffffff00, v46
    v_and_b32 v27, 0xff, v27
    v_cmp_ne_u32 s[70:71], 0, v27
    v_and_b32 v19, 0xffffff00, v47
L_g_v03:
    s_or_b64 s[72:73], s[64:65], s[66:67]
    s_or_b64 s[74:75], s[68:69], s[70:71]
    s_or_b64 s[72:73], s[72:73], s[74:75]
    s_cbranch_scc0 L_g_ok
    s_cmp_eq_u32 s78, 0
    s_cbranch_scc0 L_g_run
    s_mov_b32 s78, 1
L_g_run:
    s_cmp_eq_u32 s58, 0
    s_cbranch_scc1 L_gi_98
    s_cmp_eq_u64 s[64:65], 0
    s_cselect_b64 exec, s[76:77], s[64:65]
    buffer_load_dwordx4 v[32:35], v21, s[12:15], s60 offen sc1
    s_cmp_eq_u64 s[66:67], 0
    s_cselect_b64 exec, s[76:77], s[66:67]
    buffer_load_dwordx4 v[36:39], v21, s[12:15], s61 offen sc1
    s_cmp_eq_u64 s[68:69], 0
    s_cselect_b64 exec, s[76:77], s[68:69]
    buffer_load_dwordx4 v[40:43], v21, s[12:15], s62 offen sc1
    s_cmp_eq_u64 s[70:71], 0
    s_cselect_b64 exec, s[76:77], s[70:71]
    buffer_load_dwordx4 v[44:47], v21, s[12:15], s63 offen sc1
L_gi_98:
    s_sub_u32 s7, s7, 1
    s_cbranch_scc0 L_g_poll
    s_endpgm
L_g_ok:
    s_mov_b64 exec, -1
    v_pk_add_f32 v[4:5], v[4:5], v[12:13]
    v_pk_add_f32 v[6:7], v[6:7], v[14:15]
    v_pk_add_f32 v[8:9], v[8:9], v[16:17]
    v_pk_add_f32 v[10:11], v[10:11], v[18:19]
    v_pk_add_f32 v[4:5], v[4:5], v[8:9]
    v_pk_add_f32 v[6:7], v[6:7], v[10:11]
    s_nop 0
    v_permlane32_swap_b32 v4, v5
    v_permlane32_swap_b32 v6, v7
    v_add_f32 v4, v4, v5
    v_add_f32 v6, v6, v7
    s_nop 1
    v_permlane16_swap_b32 v4, v6
    v_add_f32 v4, v4, v6
    s_nop 1
    v_add_f32_dpp v4, v4, v4 row_ror:8 row_mask:0xf bank_mask:0xf
    ds_write_b32 v22, v4 offset:13312
    s_mov_b64 exec, 1
    ds_add_rtn_u32 v2, v1, v26 offset:56
    s_mov_b64 exec, -1
    ds_read2_b32 v[6:7], v25 offset0:64 offset1:96
    ds_read2_b32 v[4:5], v25 offset0:0 offset1:32
    ds_read2_b32 v[8:9], v25 offset0:128 offset1:160
    ds_read2_b32 v[10:11], v25 offset0:192 offset1:224
    ds_read_b32 v12, v25 offset:1024
    s_and_b32 s47, s58, 8
    s_or_b32 s47, s47, 7
    s_waitcnt lgkmcnt(5)
    v_readfirstlane_b32 s46, v2
    s_cmp_eq_u32 s46, s47
    s_cbranch_scc0 L_g_done
    s_waitcnt lgkmcnt(3)
    v_pk_add_f32 v[4:5], v[4:5], v[6:7]
    s_waitcnt lgkmcnt(1)
    v_pk_add_f32 v[8:9], v[8:9], v[10:11]
    v_pk_add_f32 v[4:5], v[4:5], v[8:9]
    s_waitcnt lgkmcnt(0)
    v_add_f32 v4, v4, v12
    v_add_f32 v4, v4, v5
    v_cvt_pk_bf16_f32 v4, v4, v4
    s_cmp_eq_u32 s58, 0
    s_cbranch_scc1 L_g_back
    s_mov_b32 exec_hi, 0
    buffer_store_short v4, v23, s[8:11], 0 offen
    s_mov_b64 exec, 1
    s_cmp_eq_u32 s2, 0
    s_cbranch_scc0 L_g_noep
    v_mov_b32 v2, s6
    buffer_store_dword v2, v1, s[12:15], 0 offen
L_g_noep:
    s_mov_b64 exec, -1
    s_endpgm
L_g_done:
    s_waitcnt lgkmcnt(0)
    s_cmp_eq_u32 s58, 0
    s_cbranch_scc1 L_g_back
    s_endpgm
L_final:
    s_waitcnt lgkmcnt(0)
    s_add_u32 s6, s6, 1
    s_cmp_eq_u32 s3, 14
    s_cbranch_scc1 L_f_go
    s_lshl_b32 s43, s4, 10
    s_xor_b32 s64, s43, 4096
    s_xor_b32 s65, s43, 8192
    s_xor_b32 s66, s43, 16384
    s_xor_b32 s67, s43, 28672
    s_xor_b32 s68, s43, 12288
    s_lshl_b32 s44, s6, 8
    s_mov_b32 s50, 0
    s_mov_b32 s41, 1
    s_mov_b32 s47, 1
    s_mov_b32 s51, 0
    v_lshlrev_b32 v7, 2, v0
L_m_loop:
    s_add_u32 s51, s51, 128
    s_and_b32 s49, s51, 896
    s_add_u32 s49, s49, 262144
    s_add_u32 s46, s44, s41
    s_cmp_ge_u32 s50, s41
    s_cbranch_scc1 L_pd_100
L_pl_99:
    ds_read_b32 v2, v1 offset:0
    s_waitcnt lgkmcnt(0)
    v_readfirstlane_b32 s50, v2
    s_cmp_ge_u32 s50, s41
    s_cbranch_scc1 L_pd_100
    s_sleep 2
    s_sub_u32 s7, s7, 1
    s_cbranch_scc0 L_pl_99
    s_endpgm
L_pd_100:
    s_cmp_eq_u32 s5, 0
    s_cbranch_scc0 L_m_nopub
    v_mov_b32 v6, s46
    s_add_u32 s45, s49, s43
    s_mov_b64 exec, 0xffff
    buffer_store_dword v6, v7, s[12:15], s45 offen sc1
    s_mov_b64 exec, -1
L_m_nopub:
    s_add_u32 s56, s49, s64
    s_load_dword s72, s[38:39], s56 glc
    s_add_u32 s57, s49, s65
    s_load_dword s73, s[38:39], s57 glc
    s_add_u32 s58, s49, s66
    s_load_dword s74, s[38:39], s58 glc
    s_add_u32 s59, s49, s67
    s_load_dword s75, s[38:39], s59 glc
    s_add_u32 s60, s49, s68
    s_load_dword s76, s[38:39], s60 glc
    s_mov_b32 s48, 0
    s_waitcnt lgkmcnt(0)
    s_sub_u32 s45, s72, s46
    s_cmp_lt_u32 s45, 128
    s_addc_u32 s48, s48, 0
    s_sub_u32 s45, s73, s46
    s_cmp_lt_u32 s45, 128
    s_addc_u32 s48, s48, 0
    s_sub_u32 s45, s74, s46
    s_cmp_lt_u32 s45, 128
    s_addc_u32 s48, s48, 0
    s_sub_u32 s45, s75, s46
    s_cmp_lt_u32 s45, 128
    s_addc_u32 s48, s48, 0
    s_sub_u32 s45, s76, s46
    s_cmp_lt_u32 s45, 128
    s_addc_u32 s48, s48, 0
    s_lshl_b32 s45, s48, 2
    s_lshr_b32 s45, 0x876054, s45
    s_and_b32 s45, s45, 15
    s_cmp_ge_u32 s48, 5
    s_cselect_b32 s48, 1, 0
    s_and_b32 s47, s47, s48
    s_cselect_b32 s45, 3, s45
    s_mov_b32 s47, s48
    v_mov_b32 v2, s45
    ds_write_b32 v1, v2 offset:28
    s_sub_u32 s45, s41, 17
    s_cmp_lt_u32 s45, 79
    s_cselect_b32 s45, 8, 4
    s_add_u32 s41, s41, s45
    s_cmp_lt_u32 s41, 120
    s_cbranch_scc1 L_m_loop
    s_endpgm
L_f_go:
    s_cmp_ge_u32 s2, 40
    s_cbranch_scc1 L_end
    v_mov_b32 v24, v0
    s_mov_b32 s40, s16
    s_mov_b32 s41, s17
    s_mov_b32 s42, 2560
    s_mov_b32 s43, 0x20000
    s_cmp_ge_u32 s2, 20
    s_cselect_b32 s44, 1, 0
    s_cselect_b32 s45, 20, 0
    s_sub_u32 s45, s2, s45
    s_lshr_b32 s46, s45, 1
    s_lshl_b32 s46, s46, 7
    s_and_b32 s47, s45, 1
    s_lshl_b32 s47, s47, 4
    s_add_u32 s46, s46, s47
    s_mul_i32 s47, s44, 1280
    s_add_u32 s46, s46, s47
    v_bfe_u32 v23, v24, 3, 1
    v_lshlrev_b32 v23, 6, v23
    v_bfe_u32 v22, v24, 4, 1
    v_lshl_add_u32 v23, v22, 5, v23
    v_and_b32 v22, 7, v24
    v_lshl_add_u32 v23, v22, 1, v23
    v_add_u32 v23, s46, v23
L_pl_101:
    ds_read_b32 v2, v1 offset:52
    s_waitcnt lgkmcnt(0)
    v_readfirstlane_b32 s46, v2
    s_cmp_ge_u32 s46, 1
    s_cbranch_scc1 L_pd_102
    s_sleep 32
    s_sub_u32 s7, s7, 1
    s_cbranch_scc0 L_pl_101
    s_endpgm
L_pd_102:
    buffer_load_ushort v6, v23, s[40:43], 0 offen
    v_and_b32 v25, 31, v24
    v_lshlrev_b32 v25, 2, v25
    v_mov_b32 v2, 1
    s_waitcnt vmcnt(0)
    v_lshlrev_b32 v6, 16, v6
    ds_write_b32 v25, v6 offset:14336
    ds_write_b32 v1, v2 offset:60
L_end:
    s_endpgm
.p2align 2
.type L_rtab,@object
L_rtab:
    .long 3865
    .long 1052
    .long 7185
    .long 4614
    .long 7172
    .long 4633
    .long 1807
    .long 6660
    .long 3854
    .long 7172
    .long 4633
    .long 2063
    .long 2052
    .long 7438
    .long 7428
    .long 4634
    .long 2064
    .long 2063
    .long 7428
    .long 4868
    .long 7685
    .long 2073
    .long 7438
    .long 4612
    .long 7439
    .long 2052
    .long 7449
    .long 4879
    .long 4881
    .long 2054
    .long 2054
    .long 7450
.size L_rtab, 128
L_pad:
s_endpgm
.section .rodata,"a"
.p2align 6
.amdhsa_kernel parallel_sum__gqa_block_cached__glu_gated_glu__decode_kernel
  .amdhsa_next_free_vgpr 128
  .amdhsa_next_free_sgpr 96
  .amdhsa_accum_offset 128
  .amdhsa_group_segment_fixed_size 0
  .amdhsa_kernarg_size 96
  .amdhsa_user_sgpr_count 2
  .amdhsa_user_sgpr_kernarg_segment_ptr 1
  .amdhsa_system_sgpr_workgroup_id_x 1
  .amdhsa_float_denorm_mode_32 3
.end_amdhsa_kernel
```
